```python
import torch

def _softmax(x, axis=-1):
    return torch.softmax(x, dim=axis)
def _gelu(x):
    return torch.nn.functional.gelu(x, approximate="tanh")
def _silu(x):
    return torch.nn.functional.silu(x)
def _sigmoid(x):
    return torch.sigmoid(x)
def _layernorm(x, axis=-1, eps=1e-5):
    m = x.mean(dim=axis, keepdim=True)
    v = x.var(dim=axis, keepdim=True, unbiased=False)
    return (x - m) / torch.sqrt(v + eps)
def _scatter_add(tgt, idx, src, axis=0):
    return tgt.clone().index_add_(axis, idx, src)
def _segment_sum(src, seg, n):
    out = torch.zeros((n,) + src.shape[1:], dtype=src.dtype)
    return out.index_add_(0, seg, src)
def _pad(x, pw):
    flat = tuple(v for pair in reversed(pw) for v in pair)
    return torch.nn.functional.pad(x, flat)

kernel_name = 'recurrent_scan__gqa_block_cached__mixer_channel_mlp__prompt'

def setup_inputs():

    _w = (lambda a: (lambda t: t.to(torch.bfloat16) if t.is_floating_point() else t)(torch.as_tensor(a)))
    def _A_setup():
        B, Sq, D = 1, 2048, 640
        Hq, Hkv, Sk, Dh = 32, 32, 2048, 192
        assert Hq % Hkv == 0, (Hq, Hkv)
        return {
            "x": _w((lambda *s: torch.randn(*s, dtype=torch.bfloat16) * 0.05)(B, Sq, D)),
            "k_cache": _w((lambda *s: torch.randn(*s, dtype=torch.bfloat16) * 1.6)(B, Hkv, Sk, Dh)),
            "v_cache": _w((lambda *s: torch.randn(*s, dtype=torch.bfloat16) * 0.8)(B, Hkv, Sk, Dh)),
            "wq": _w((lambda *s: torch.randn(*s, dtype=torch.bfloat16) * 1.6)(D, Hq * Dh) * (D ** -0.5)),
            "wo": _w((lambda *s: torch.randn(*s, dtype=torch.bfloat16) * 0.8)(Hq * Dh, D) * ((Hq * Dh) ** -0.5)),
        }
    _A_in = _A_setup()

    def _B_setup():
        B, S, D, F = 1, 2048, 640, 1536
        return {
            "x": _w((lambda *s: torch.randn(*s, dtype=torch.bfloat16) * 0.05)(B, S, D)),
            "w1": _w((lambda *s: torch.randn(*s, dtype=torch.bfloat16) * 3.2)(D, F) * (D ** -0.5)),
            "b1": _w((lambda *s: torch.randn(*s, dtype=torch.bfloat16) * 1.6)(F)),
            "w2": _w((lambda *s: torch.randn(*s, dtype=torch.bfloat16) * 0.2)(F, D) * (F ** -0.5)),
            "b2": _w((lambda *s: torch.randn(*s, dtype=torch.bfloat16) * 0.2)(D)),
        }
    _B_in = _B_setup()

    return {
        "A_x": _A_in["x"],
        "A_k_cache": _A_in["k_cache"],
        "A_v_cache": _A_in["v_cache"],
        "A_wq": _A_in["wq"],
        "A_wo": _A_in["wo"],
        "B_x": _B_in["x"],
        "B_w1": _B_in["w1"],
        "B_b1": _B_in["b1"],
        "B_w2": _B_in["w2"],
        "B_b2": _B_in["b2"],
    }

def reference(A_x, A_k_cache, A_v_cache, A_wq, A_wo, B_x, B_w1, B_b1, B_w2, B_b2):
    def _A_ref(x, k_cache, v_cache, wq, wo):
        B, Sq, D = x.shape
        Hq, Dh = 32, 192
        Hkv = k_cache.shape[1]
        rep = Hq // Hkv
        q = (lambda x, *d: x.permute(*d))((x @ wq).reshape(B, Sq, Hq, Dh), 0, 2, 1, 3)
        k = (lambda x, n, axis: torch.repeat_interleave(x, n, dim=axis))(k_cache, rep, axis=1)
        v = (lambda x, n, axis: torch.repeat_interleave(x, n, dim=axis))(v_cache, rep, axis=1)
        scores = torch.einsum("bhqd,bhkd->bhqk", q, k) * (Dh ** -0.5)
        p = _softmax(scores, axis=-1)
        o = torch.einsum("bhqk,bhkd->bhqd", p, v)
        return (lambda x, *d: x.permute(*d))(o, 0, 2, 1, 3).reshape(B, Sq, Hq * Dh) @ wo

    def _B_ref(x, w1, b1, w2, b2):
        y = _layernorm(x, axis=-1)
        h = _gelu(torch.einsum("bsd,df->bsf", y, w1) + b1)
        return torch.einsum("bsf,fd->bsd", h, w2) + b2

    x = A_x
    xn = _layernorm(x, axis=-1)
    s = _A_ref(xn, A_k_cache, A_v_cache, A_wq, A_wo)
    g = _silu(_B_ref(xn, B_w1, B_b1, B_w2, B_b2))
    return x + s * g
```

```asm
; @launch kernel=ln_kernel grid=(512,1,1) block=(256,1,1) lds=0
; @launch kernel=proj_kernel grid=(960,1,1) block=(256,1,1) lds=65536
; @launch kernel=attn_kernel grid=(256,1,1) block=(512,1,1) lds=98304
; @launch kernel=outk_kernel grid=(400,1,1) block=(256,1,1) lds=98304
; @launch kernel=fin_kernel grid=(1280,1,1) block=(256,1,1) lds=0
.amdgcn_target "amdgcn-amd-amdhsa--gfx950"
.text
.globl ln_kernel
.p2align 8
.type ln_kernel,@function
ln_kernel:
    s_cmp_ge_u32 s2, 512
    s_cbranch_scc1 L_ln_done
    s_load_dwordx2 s[4:5], s[0:1], 0
    s_load_dwordx2 s[6:7], s[0:1], 96
    s_waitcnt lgkmcnt(0)
    s_mov_b32 s8, s4
    s_and_b32 s9, s5, 0xffff
    s_mov_b32 s10, 2621440
    s_mov_b32 s11, 0x00020000
    s_mov_b32 s12, s6
    s_and_b32 s13, s7, 0xffff
    s_mov_b32 s14, 5242880
    s_mov_b32 s15, 0x00020000
    v_lshrrev_b32 v1, 6, v0
    s_lshl_b32 s3, s2, 2
    v_add_u32 v1, s3, v1
    v_mul_u32_u24 v1, 1280, v1
    v_and_b32 v2, 63, v0
    v_lshl_add_u32 v1, v2, 2, v1
    buffer_load_dword v10, v1, s[8:11], 0 offen offset:0
    buffer_load_dword v11, v1, s[8:11], 0 offen offset:256
    buffer_load_dword v12, v1, s[8:11], 0 offen offset:512
    buffer_load_dword v13, v1, s[8:11], 0 offen offset:768
    buffer_load_dword v14, v1, s[8:11], 0 offen offset:1024
    s_waitcnt vmcnt(0)
    v_lshlrev_b32 v20, 16, v10
    v_and_b32 v21, 0xffff0000, v10
    v_lshlrev_b32 v22, 16, v11
    v_and_b32 v23, 0xffff0000, v11
    v_lshlrev_b32 v24, 16, v12
    v_and_b32 v25, 0xffff0000, v12
    v_lshlrev_b32 v26, 16, v13
    v_and_b32 v27, 0xffff0000, v13
    v_lshlrev_b32 v28, 16, v14
    v_and_b32 v29, 0xffff0000, v14
    s_mov_b32 s16, 0x3acccccd
    s_mov_b32 s17, 0x3727c5ac
    v_add_f32 v3, v20, v21
    v_add_f32 v3, v3, v22
    v_add_f32 v3, v3, v23
    v_add_f32 v3, v3, v24
    v_add_f32 v3, v3, v25
    v_add_f32 v3, v3, v26
    v_add_f32 v3, v3, v27
    v_add_f32 v3, v3, v28
    v_add_f32 v3, v3, v29
    ds_swizzle_b32 v4, v3 offset:0x41f
    s_waitcnt lgkmcnt(0)
    v_add_f32 v3, v3, v4
    ds_swizzle_b32 v4, v3 offset:0x81f
    s_waitcnt lgkmcnt(0)
    v_add_f32 v3, v3, v4
    ds_swizzle_b32 v4, v3 offset:0x101f
    s_waitcnt lgkmcnt(0)
    v_add_f32 v3, v3, v4
    ds_swizzle_b32 v4, v3 offset:0x201f
    s_waitcnt lgkmcnt(0)
    v_add_f32 v3, v3, v4
    ds_swizzle_b32 v4, v3 offset:0x401f
    s_waitcnt lgkmcnt(0)
    v_add_f32 v3, v3, v4
    v_mov_b32 v4, v3
    v_mov_b32 v5, v3
    s_nop 1
    v_permlane32_swap_b32 v4, v5
    s_nop 1
    v_add_f32 v3, v4, v5
    v_mul_f32 v3, s16, v3
    v_sub_f32 v6, v20, v3
    v_mul_f32 v7, v6, v6
    v_sub_f32 v6, v21, v3
    v_fmac_f32 v7, v6, v6
    v_sub_f32 v6, v22, v3
    v_fmac_f32 v7, v6, v6
    v_sub_f32 v6, v23, v3
    v_fmac_f32 v7, v6, v6
    v_sub_f32 v6, v24, v3
    v_fmac_f32 v7, v6, v6
    v_sub_f32 v6, v25, v3
    v_fmac_f32 v7, v6, v6
    v_sub_f32 v6, v26, v3
    v_fmac_f32 v7, v6, v6
    v_sub_f32 v6, v27, v3
    v_fmac_f32 v7, v6, v6
    v_sub_f32 v6, v28, v3
    v_fmac_f32 v7, v6, v6
    v_sub_f32 v6, v29, v3
    v_fmac_f32 v7, v6, v6
    ds_swizzle_b32 v4, v7 offset:0x41f
    s_waitcnt lgkmcnt(0)
    v_add_f32 v7, v7, v4
    ds_swizzle_b32 v4, v7 offset:0x81f
    s_waitcnt lgkmcnt(0)
    v_add_f32 v7, v7, v4
    ds_swizzle_b32 v4, v7 offset:0x101f
    s_waitcnt lgkmcnt(0)
    v_add_f32 v7, v7, v4
    ds_swizzle_b32 v4, v7 offset:0x201f
    s_waitcnt lgkmcnt(0)
    v_add_f32 v7, v7, v4
    ds_swizzle_b32 v4, v7 offset:0x401f
    s_waitcnt lgkmcnt(0)
    v_add_f32 v7, v7, v4
    v_mov_b32 v4, v7
    v_mov_b32 v5, v7
    s_nop 1
    v_permlane32_swap_b32 v4, v5
    s_nop 1
    v_add_f32 v7, v4, v5
    v_mul_f32 v7, s16, v7
    v_cvt_pk_bf16_f32 v3, v3, v3
    v_lshlrev_b32 v3, 16, v3
    v_cvt_pk_bf16_f32 v7, v7, v7
    v_lshlrev_b32 v7, 16, v7
    v_add_f32 v7, s17, v7
    v_cvt_pk_bf16_f32 v7, v7, v7
    v_lshlrev_b32 v7, 16, v7
    v_sqrt_f32 v7, v7
    s_nop 0
    v_cvt_pk_bf16_f32 v7, v7, v7
    v_lshlrev_b32 v7, 16, v7
    v_rcp_f32 v7, v7
    s_nop 0
    v_sub_f32 v6, v20, v3
    v_cvt_pk_bf16_f32 v6, v6, v6
    v_lshlrev_b32 v6, 16, v6
    v_mul_f32 v20, v6, v7
    v_sub_f32 v6, v21, v3
    v_cvt_pk_bf16_f32 v6, v6, v6
    v_lshlrev_b32 v6, 16, v6
    v_mul_f32 v21, v6, v7
    v_sub_f32 v6, v22, v3
    v_cvt_pk_bf16_f32 v6, v6, v6
    v_lshlrev_b32 v6, 16, v6
    v_mul_f32 v22, v6, v7
    v_sub_f32 v6, v23, v3
    v_cvt_pk_bf16_f32 v6, v6, v6
    v_lshlrev_b32 v6, 16, v6
    v_mul_f32 v23, v6, v7
    v_sub_f32 v6, v24, v3
    v_cvt_pk_bf16_f32 v6, v6, v6
    v_lshlrev_b32 v6, 16, v6
    v_mul_f32 v24, v6, v7
    v_sub_f32 v6, v25, v3
    v_cvt_pk_bf16_f32 v6, v6, v6
    v_lshlrev_b32 v6, 16, v6
    v_mul_f32 v25, v6, v7
    v_sub_f32 v6, v26, v3
    v_cvt_pk_bf16_f32 v6, v6, v6
    v_lshlrev_b32 v6, 16, v6
    v_mul_f32 v26, v6, v7
    v_sub_f32 v6, v27, v3
    v_cvt_pk_bf16_f32 v6, v6, v6
    v_lshlrev_b32 v6, 16, v6
    v_mul_f32 v27, v6, v7
    v_sub_f32 v6, v28, v3
    v_cvt_pk_bf16_f32 v6, v6, v6
    v_lshlrev_b32 v6, 16, v6
    v_mul_f32 v28, v6, v7
    v_sub_f32 v6, v29, v3
    v_cvt_pk_bf16_f32 v6, v6, v6
    v_lshlrev_b32 v6, 16, v6
    v_mul_f32 v29, v6, v7
    v_cvt_pk_bf16_f32 v10, v20, v21
    v_cvt_pk_bf16_f32 v11, v22, v23
    v_cvt_pk_bf16_f32 v12, v24, v25
    v_cvt_pk_bf16_f32 v13, v26, v27
    v_cvt_pk_bf16_f32 v14, v28, v29
    buffer_store_dword v10, v1, s[12:15], 0 offen offset:0
    buffer_store_dword v11, v1, s[12:15], 0 offen offset:256
    buffer_store_dword v12, v1, s[12:15], 0 offen offset:512
    buffer_store_dword v13, v1, s[12:15], 0 offen offset:768
    buffer_store_dword v14, v1, s[12:15], 0 offen offset:1024
    s_nop 1
    v_lshlrev_b32 v20, 16, v10
    v_and_b32 v21, 0xffff0000, v10
    v_lshlrev_b32 v22, 16, v11
    v_and_b32 v23, 0xffff0000, v11
    v_lshlrev_b32 v24, 16, v12
    v_and_b32 v25, 0xffff0000, v12
    v_lshlrev_b32 v26, 16, v13
    v_and_b32 v27, 0xffff0000, v13
    v_lshlrev_b32 v28, 16, v14
    v_and_b32 v29, 0xffff0000, v14
    v_add_f32 v3, v20, v21
    v_add_f32 v3, v3, v22
    v_add_f32 v3, v3, v23
    v_add_f32 v3, v3, v24
    v_add_f32 v3, v3, v25
    v_add_f32 v3, v3, v26
    v_add_f32 v3, v3, v27
    v_add_f32 v3, v3, v28
    v_add_f32 v3, v3, v29
    ds_swizzle_b32 v4, v3 offset:0x41f
    s_waitcnt lgkmcnt(0)
    v_add_f32 v3, v3, v4
    ds_swizzle_b32 v4, v3 offset:0x81f
    s_waitcnt lgkmcnt(0)
    v_add_f32 v3, v3, v4
    ds_swizzle_b32 v4, v3 offset:0x101f
    s_waitcnt lgkmcnt(0)
    v_add_f32 v3, v3, v4
    ds_swizzle_b32 v4, v3 offset:0x201f
    s_waitcnt lgkmcnt(0)
    v_add_f32 v3, v3, v4
    ds_swizzle_b32 v4, v3 offset:0x401f
    s_waitcnt lgkmcnt(0)
    v_add_f32 v3, v3, v4
    v_mov_b32 v4, v3
    v_mov_b32 v5, v3
    s_nop 1
    v_permlane32_swap_b32 v4, v5
    s_nop 1
    v_add_f32 v3, v4, v5
    v_mul_f32 v3, s16, v3
    v_sub_f32 v6, v20, v3
    v_mul_f32 v7, v6, v6
    v_sub_f32 v6, v21, v3
    v_fmac_f32 v7, v6, v6
    v_sub_f32 v6, v22, v3
    v_fmac_f32 v7, v6, v6
    v_sub_f32 v6, v23, v3
    v_fmac_f32 v7, v6, v6
    v_sub_f32 v6, v24, v3
    v_fmac_f32 v7, v6, v6
    v_sub_f32 v6, v25, v3
    v_fmac_f32 v7, v6, v6
    v_sub_f32 v6, v26, v3
    v_fmac_f32 v7, v6, v6
    v_sub_f32 v6, v27, v3
    v_fmac_f32 v7, v6, v6
    v_sub_f32 v6, v28, v3
    v_fmac_f32 v7, v6, v6
    v_sub_f32 v6, v29, v3
    v_fmac_f32 v7, v6, v6
    ds_swizzle_b32 v4, v7 offset:0x41f
    s_waitcnt lgkmcnt(0)
    v_add_f32 v7, v7, v4
    ds_swizzle_b32 v4, v7 offset:0x81f
    s_waitcnt lgkmcnt(0)
    v_add_f32 v7, v7, v4
    ds_swizzle_b32 v4, v7 offset:0x101f
    s_waitcnt lgkmcnt(0)
    v_add_f32 v7, v7, v4
    ds_swizzle_b32 v4, v7 offset:0x201f
    s_waitcnt lgkmcnt(0)
    v_add_f32 v7, v7, v4
    ds_swizzle_b32 v4, v7 offset:0x401f
    s_waitcnt lgkmcnt(0)
    v_add_f32 v7, v7, v4
    v_mov_b32 v4, v7
    v_mov_b32 v5, v7
    s_nop 1
    v_permlane32_swap_b32 v4, v5
    s_nop 1
    v_add_f32 v7, v4, v5
    v_mul_f32 v7, s16, v7
    v_cvt_pk_bf16_f32 v3, v3, v3
    v_lshlrev_b32 v3, 16, v3
    v_cvt_pk_bf16_f32 v7, v7, v7
    v_lshlrev_b32 v7, 16, v7
    v_add_f32 v7, s17, v7
    v_cvt_pk_bf16_f32 v7, v7, v7
    v_lshlrev_b32 v7, 16, v7
    v_sqrt_f32 v7, v7
    s_nop 0
    v_cvt_pk_bf16_f32 v7, v7, v7
    v_lshlrev_b32 v7, 16, v7
    v_rcp_f32 v7, v7
    s_nop 0
    v_sub_f32 v6, v20, v3
    v_cvt_pk_bf16_f32 v6, v6, v6
    v_lshlrev_b32 v6, 16, v6
    v_mul_f32 v20, v6, v7
    v_sub_f32 v6, v21, v3
    v_cvt_pk_bf16_f32 v6, v6, v6
    v_lshlrev_b32 v6, 16, v6
    v_mul_f32 v21, v6, v7
    v_sub_f32 v6, v22, v3
    v_cvt_pk_bf16_f32 v6, v6, v6
    v_lshlrev_b32 v6, 16, v6
    v_mul_f32 v22, v6, v7
    v_sub_f32 v6, v23, v3
    v_cvt_pk_bf16_f32 v6, v6, v6
    v_lshlrev_b32 v6, 16, v6
    v_mul_f32 v23, v6, v7
    v_sub_f32 v6, v24, v3
    v_cvt_pk_bf16_f32 v6, v6, v6
    v_lshlrev_b32 v6, 16, v6
    v_mul_f32 v24, v6, v7
    v_sub_f32 v6, v25, v3
    v_cvt_pk_bf16_f32 v6, v6, v6
    v_lshlrev_b32 v6, 16, v6
    v_mul_f32 v25, v6, v7
    v_sub_f32 v6, v26, v3
    v_cvt_pk_bf16_f32 v6, v6, v6
    v_lshlrev_b32 v6, 16, v6
    v_mul_f32 v26, v6, v7
    v_sub_f32 v6, v27, v3
    v_cvt_pk_bf16_f32 v6, v6, v6
    v_lshlrev_b32 v6, 16, v6
    v_mul_f32 v27, v6, v7
    v_sub_f32 v6, v28, v3
    v_cvt_pk_bf16_f32 v6, v6, v6
    v_lshlrev_b32 v6, 16, v6
    v_mul_f32 v28, v6, v7
    v_sub_f32 v6, v29, v3
    v_cvt_pk_bf16_f32 v6, v6, v6
    v_lshlrev_b32 v6, 16, v6
    v_mul_f32 v29, v6, v7
    v_cvt_pk_bf16_f32 v10, v20, v21
    v_cvt_pk_bf16_f32 v11, v22, v23
    v_cvt_pk_bf16_f32 v12, v24, v25
    v_cvt_pk_bf16_f32 v13, v26, v27
    v_cvt_pk_bf16_f32 v14, v28, v29
    s_mov_b32 s18, 2621440
    buffer_store_dword v10, v1, s[12:15], s18 offen offset:0
    s_mov_b32 s18, 2621440
    buffer_store_dword v11, v1, s[12:15], s18 offen offset:256
    s_mov_b32 s18, 2621440
    buffer_store_dword v12, v1, s[12:15], s18 offen offset:512
    s_mov_b32 s18, 2621440
    buffer_store_dword v13, v1, s[12:15], s18 offen offset:768
    s_mov_b32 s18, 2621440
    buffer_store_dword v14, v1, s[12:15], s18 offen offset:1024
    s_waitcnt vmcnt(0)
L_ln_done:
    s_endpgm
.globl proj_kernel
.p2align 8
.type proj_kernel,@function
proj_kernel:
    s_cmp_ge_u32 s2, 960
    s_cbranch_scc1 L_proj_done
    s_load_dwordx2 s[4:5], s[0:1], 96
    s_load_dwordx2 s[6:7], s[0:1], 24
    s_load_dwordx2 s[8:9], s[0:1], 48
    s_load_dwordx2 s[10:11], s[0:1], 56
    v_lshrrev_b32 v1, 6, v0
    s_nop 0
    v_readfirstlane_b32 s3, v1
    s_and_b32 s24, s2, 15
    s_lshr_b32 s25, s2, 4
    s_waitcnt lgkmcnt(0)
    s_cmp_lt_u32 s25, 48
    s_cbranch_scc0 L_proj_mlp
    s_add_u32 s12, s4, 0
    s_addc_u32 s13, s5, 0
    s_mov_b32 s28, s12
    s_and_b32 s29, s13, 0xffff
    s_mov_b32 s30, 2621440
    s_mov_b32 s31, 0x00020000
    s_mov_b32 s32, s6
    s_and_b32 s33, s7, 0xffff
    s_mov_b32 s34, 7864320
    s_mov_b32 s35, 0x00020000
    s_add_u32 s12, s4, 5242880
    s_addc_u32 s13, s5, 0
    s_mov_b32 s36, s12
    s_and_b32 s37, s13, 0xffff
    s_mov_b32 s38, 25165824
    s_mov_b32 s39, 0x00020000
    s_mov_b32 s26, 12288
    s_branch L_proj_go
L_proj_mlp:
    s_sub_u32 s25, s25, 48
    s_add_u32 s12, s4, 2621440
    s_addc_u32 s13, s5, 0
    s_mov_b32 s28, s12
    s_and_b32 s29, s13, 0xffff
    s_mov_b32 s30, 2621440
    s_mov_b32 s31, 0x00020000
    s_mov_b32 s32, s8
    s_and_b32 s33, s9, 0xffff
    s_mov_b32 s34, 1966080
    s_mov_b32 s35, 0x00020000
    s_add_u32 s12, s4, 30408704
    s_addc_u32 s13, s5, 0
    s_mov_b32 s36, s12
    s_and_b32 s37, s13, 0xffff
    s_mov_b32 s38, 6291456
    s_mov_b32 s39, 0x00020000
    s_mov_b32 s26, 3072
L_proj_go:
    s_mov_b32 s40, s10
    s_and_b32 s41, s11, 0xffff
    s_mov_b32 s42, 3072
    s_mov_b32 s43, 0x00020000
    v_and_b32 v112, 31, v0
    v_bfe_u32 v113, v0, 5, 1
    s_lshr_b32 s20, s3, 1
    s_and_b32 s21, s3, 1
    s_mul_i32 s22, s20, 8192
    v_lshlrev_b32 v114, 7, v112
    v_add_u32 v114, s22, v114
    v_bfe_u32 v115, v0, 1, 3
    v_add_u32 v116, 0, v113
    v_xor_b32 v116, v116, v115
    v_lshl_add_u32 v2, v116, 4, v114
    v_add_u32 v116, 2, v113
    v_xor_b32 v116, v116, v115
    v_lshl_add_u32 v3, v116, 4, v114
    v_add_u32 v116, 4, v113
    v_xor_b32 v116, v116, v115
    v_lshl_add_u32 v4, v116, 4, v114
    v_add_u32 v116, 6, v113
    v_xor_b32 v116, v116, v115
    v_lshl_add_u32 v5, v116, 4, v114
    v_bfe_u32 v112, v0, 2, 2
    v_lshl_add_u32 v114, v113, 3, v112
    v_mul_u32_u24 v114, 256, v114
    v_and_b32 v115, 1, v0
    v_lshl_add_u32 v114, v115, 3, v114
    v_add_u32 v114, 16384, v114
    v_lshlrev_b32 v115, 2, v112
    v_bfe_u32 v116, v0, 4, 1
    v_bfe_u32 v117, v0, 1, 1
    v_lshl_add_u32 v116, v116, 1, v117
    s_mul_i32 s22, s21, 8
    v_add_u32 v116, s22, v116
    v_add_u32 v117, 0, v116
    v_xor_b32 v117, v117, v115
    v_lshl_add_u32 v6, v117, 4, v114
    v_add_u32 v117, 4, v116
    v_xor_b32 v117, v117, v115
    v_lshl_add_u32 v7, v117, 4, v114
    s_cmp_eq_u32 s26, 12288
    s_cbranch_scc0 L_proj_dma2
    v_and_b32 v112, 63, v0
    s_mul_i32 s22, s3, 256
    s_add_u32 s22, s22, 0
    v_add_u32 v113, s22, v112
    v_lshrrev_b32 v114, 3, v113
    v_and_b32 v115, 7, v113
    v_bfe_u32 v116, v114, 1, 3
    v_xor_b32 v115, v115, v116
    v_mul_u32_u24 v114, 1280, v114
    v_lshl_add_u32 v8, v115, 4, v114
    s_mul_i32 s22, s3, 256
    s_add_u32 s22, s22, 64
    v_add_u32 v113, s22, v112
    v_lshrrev_b32 v114, 3, v113
    v_and_b32 v115, 7, v113
    v_bfe_u32 v116, v114, 1, 3
    v_xor_b32 v115, v115, v116
    v_mul_u32_u24 v114, 1280, v114
    v_lshl_add_u32 v9, v115, 4, v114
    s_mul_i32 s22, s3, 256
    s_add_u32 s22, s22, 128
    v_add_u32 v113, s22, v112
    v_lshrrev_b32 v114, 3, v113
    v_and_b32 v115, 7, v113
    v_bfe_u32 v116, v114, 1, 3
    v_xor_b32 v115, v115, v116
    v_mul_u32_u24 v114, 1280, v114
    v_lshl_add_u32 v10, v115, 4, v114
    s_mul_i32 s22, s3, 256
    s_add_u32 s22, s22, 192
    v_add_u32 v113, s22, v112
    v_lshrrev_b32 v114, 3, v113
    v_and_b32 v115, 7, v113
    v_bfe_u32 v116, v114, 1, 3
    v_xor_b32 v115, v115, v116
    v_mul_u32_u24 v114, 1280, v114
    v_lshl_add_u32 v11, v115, 4, v114
    s_mul_i32 s22, s3, 256
    s_add_u32 s22, s22, 0
    v_add_u32 v113, s22, v112
    v_lshrrev_b32 v114, 4, v113
    v_and_b32 v115, 15, v113
    v_and_b32 v116, 3, v114
    v_lshlrev_b32 v116, 2, v116
    v_xor_b32 v115, v115, v116
    v_mul_u32_u24 v114, 12288, v114
    v_lshl_add_u32 v12, v115, 4, v114
    s_mul_i32 s22, s3, 256
    s_add_u32 s22, s22, 64
    v_add_u32 v113, s22, v112
    v_lshrrev_b32 v114, 4, v113
    v_and_b32 v115, 15, v113
    v_and_b32 v116, 3, v114
    v_lshlrev_b32 v116, 2, v116
    v_xor_b32 v115, v115, v116
    v_mul_u32_u24 v114, 12288, v114
    v_lshl_add_u32 v13, v115, 4, v114
    s_mul_i32 s22, s3, 256
    s_add_u32 s22, s22, 128
    v_add_u32 v113, s22, v112
    v_lshrrev_b32 v114, 4, v113
    v_and_b32 v115, 15, v113
    v_and_b32 v116, 3, v114
    v_lshlrev_b32 v116, 2, v116
    v_xor_b32 v115, v115, v116
    v_mul_u32_u24 v114, 12288, v114
    v_lshl_add_u32 v14, v115, 4, v114
    s_mul_i32 s22, s3, 256
    s_add_u32 s22, s22, 192
    v_add_u32 v113, s22, v112
    v_lshrrev_b32 v114, 4, v113
    v_and_b32 v115, 15, v113
    v_and_b32 v116, 3, v114
    v_lshlrev_b32 v116, 2, v116
    v_xor_b32 v115, v115, v116
    v_mul_u32_u24 v114, 12288, v114
    v_lshl_add_u32 v15, v115, 4, v114
    s_branch L_proj_dma_done
L_proj_dma2:
    v_and_b32 v112, 63, v0
    s_mul_i32 s22, s3, 256
    s_add_u32 s22, s22, 0
    v_add_u32 v113, s22, v112
    v_lshrrev_b32 v114, 3, v113
    v_and_b32 v115, 7, v113
    v_bfe_u32 v116, v114, 1, 3
    v_xor_b32 v115, v115, v116
    v_mul_u32_u24 v114, 1280, v114
    v_lshl_add_u32 v8, v115, 4, v114
    s_mul_i32 s22, s3, 256
    s_add_u32 s22, s22, 64
    v_add_u32 v113, s22, v112
    v_lshrrev_b32 v114, 3, v113
    v_and_b32 v115, 7, v113
    v_bfe_u32 v116, v114, 1, 3
    v_xor_b32 v115, v115, v116
    v_mul_u32_u24 v114, 1280, v114
    v_lshl_add_u32 v9, v115, 4, v114
    s_mul_i32 s22, s3, 256
    s_add_u32 s22, s22, 128
    v_add_u32 v113, s22, v112
    v_lshrrev_b32 v114, 3, v113
    v_and_b32 v115, 7, v113
    v_bfe_u32 v116, v114, 1, 3
    v_xor_b32 v115, v115, v116
    v_mul_u32_u24 v114, 1280, v114
    v_lshl_add_u32 v10, v115, 4, v114
    s_mul_i32 s22, s3, 256
    s_add_u32 s22, s22, 192
    v_add_u32 v113, s22, v112
    v_lshrrev_b32 v114, 3, v113
    v_and_b32 v115, 7, v113
    v_bfe_u32 v116, v114, 1, 3
    v_xor_b32 v115, v115, v116
    v_mul_u32_u24 v114, 1280, v114
    v_lshl_add_u32 v11, v115, 4, v114
    s_mul_i32 s22, s3, 256
    s_add_u32 s22, s22, 0
    v_add_u32 v113, s22, v112
    v_lshrrev_b32 v114, 4, v113
    v_and_b32 v115, 15, v113
    v_and_b32 v116, 3, v114
    v_lshlrev_b32 v116, 2, v116
    v_xor_b32 v115, v115, v116
    v_mul_u32_u24 v114, 3072, v114
    v_lshl_add_u32 v12, v115, 4, v114
    s_mul_i32 s22, s3, 256
    s_add_u32 s22, s22, 64
    v_add_u32 v113, s22, v112
    v_lshrrev_b32 v114, 4, v113
    v_and_b32 v115, 15, v113
    v_and_b32 v116, 3, v114
    v_lshlrev_b32 v116, 2, v116
    v_xor_b32 v115, v115, v116
    v_mul_u32_u24 v114, 3072, v114
    v_lshl_add_u32 v13, v115, 4, v114
    s_mul_i32 s22, s3, 256
    s_add_u32 s22, s22, 128
    v_add_u32 v113, s22, v112
    v_lshrrev_b32 v114, 4, v113
    v_and_b32 v115, 15, v113
    v_and_b32 v116, 3, v114
    v_lshlrev_b32 v116, 2, v116
    v_xor_b32 v115, v115, v116
    v_mul_u32_u24 v114, 3072, v114
    v_lshl_add_u32 v14, v115, 4, v114
    s_mul_i32 s22, s3, 256
    s_add_u32 s22, s22, 192
    v_add_u32 v113, s22, v112
    v_lshrrev_b32 v114, 4, v113
    v_and_b32 v115, 15, v113
    v_and_b32 v116, 3, v114
    v_lshlrev_b32 v116, 2, v116
    v_xor_b32 v115, v115, v116
    v_mul_u32_u24 v114, 3072, v114
    v_lshl_add_u32 v15, v115, 4, v114
L_proj_dma_done:
    v_mov_b32 v48, 0
    v_mov_b32 v49, 0
    v_mov_b32 v50, 0
    v_mov_b32 v51, 0
    v_mov_b32 v52, 0
    v_mov_b32 v53, 0
    v_mov_b32 v54, 0
    v_mov_b32 v55, 0
    v_mov_b32 v56, 0
    v_mov_b32 v57, 0
    v_mov_b32 v58, 0
    v_mov_b32 v59, 0
    v_mov_b32 v60, 0
    v_mov_b32 v61, 0
    v_mov_b32 v62, 0
    v_mov_b32 v63, 0
    v_mov_b32 v64, 0
    v_mov_b32 v65, 0
    v_mov_b32 v66, 0
    v_mov_b32 v67, 0
    v_mov_b32 v68, 0
    v_mov_b32 v69, 0
    v_mov_b32 v70, 0
    v_mov_b32 v71, 0
    v_mov_b32 v72, 0
    v_mov_b32 v73, 0
    v_mov_b32 v74, 0
    v_mov_b32 v75, 0
    v_mov_b32 v76, 0
    v_mov_b32 v77, 0
    v_mov_b32 v78, 0
    v_mov_b32 v79, 0
    v_mov_b32 v80, 0
    v_mov_b32 v81, 0
    v_mov_b32 v82, 0
    v_mov_b32 v83, 0
    v_mov_b32 v84, 0
    v_mov_b32 v85, 0
    v_mov_b32 v86, 0
    v_mov_b32 v87, 0
    v_mov_b32 v88, 0
    v_mov_b32 v89, 0
    v_mov_b32 v90, 0
    v_mov_b32 v91, 0
    v_mov_b32 v92, 0
    v_mov_b32 v93, 0
    v_mov_b32 v94, 0
    v_mov_b32 v95, 0
    v_mov_b32 v96, 0
    v_mov_b32 v97, 0
    v_mov_b32 v98, 0
    v_mov_b32 v99, 0
    v_mov_b32 v100, 0
    v_mov_b32 v101, 0
    v_mov_b32 v102, 0
    v_mov_b32 v103, 0
    v_mov_b32 v104, 0
    v_mov_b32 v105, 0
    v_mov_b32 v106, 0
    v_mov_b32 v107, 0
    v_mov_b32 v108, 0
    v_mov_b32 v109, 0
    v_mov_b32 v110, 0
    v_mov_b32 v111, 0
    s_mul_i32 s44, s24, 163840
    s_lshl_b32 s45, s25, 8
    s_cmp_eq_u32 s26, 12288
    s_cbranch_scc0 L_proj_loop2
    s_mul_i32 s22, s3, 4096
    s_add_u32 s22, s22, 0
    s_mov_b32 m0, s22
    s_add_u32 s22, s22, 1024
    buffer_load_dwordx4 v8, s[28:31], s44 offen lds
    s_mov_b32 m0, s22
    s_add_u32 s22, s22, 1024
    buffer_load_dwordx4 v9, s[28:31], s44 offen lds
    s_mov_b32 m0, s22
    s_add_u32 s22, s22, 1024
    buffer_load_dwordx4 v10, s[28:31], s44 offen lds
    s_mov_b32 m0, s22
    s_add_u32 s22, s22, 1024
    buffer_load_dwordx4 v11, s[28:31], s44 offen lds
    s_mul_i32 s22, s3, 4096
    s_add_u32 s22, s22, 16384
    s_mov_b32 m0, s22
    s_add_u32 s22, s22, 1024
    buffer_load_dwordx4 v12, s[32:35], s45 offen lds
    s_mov_b32 m0, s22
    s_add_u32 s22, s22, 1024
    buffer_load_dwordx4 v13, s[32:35], s45 offen lds
    s_mov_b32 m0, s22
    s_add_u32 s22, s22, 1024
    buffer_load_dwordx4 v14, s[32:35], s45 offen lds
    s_mov_b32 m0, s22
    s_add_u32 s22, s22, 1024
    buffer_load_dwordx4 v15, s[32:35], s45 offen lds
    s_add_u32 s44, s44, 128
    s_add_u32 s45, s45, 786432
    s_mov_b32 s23, 0
L_projq_loop:
    s_waitcnt vmcnt(0)
    s_barrier
    ds_read_b128 v[16:19], v2 offset:0
    ds_read_b128 v[20:23], v2 offset:4096
    ds_read_b64_tr_b16 v[32:33], v6 offset:0
    ds_read_b64_tr_b16 v[34:35], v6 offset:1024
    ds_read_b64_tr_b16 v[36:37], v7 offset:0
    ds_read_b64_tr_b16 v[38:39], v7 offset:1024
    ds_read_b128 v[24:27], v3 offset:0
    ds_read_b128 v[28:31], v3 offset:4096
    ds_read_b64_tr_b16 v[40:41], v6 offset:4096
    ds_read_b64_tr_b16 v[42:43], v6 offset:5120
    ds_read_b64_tr_b16 v[44:45], v7 offset:4096
    ds_read_b64_tr_b16 v[46:47], v7 offset:5120
    s_waitcnt lgkmcnt(6)
    v_mfma_f32_32x32x16_bf16 v[48:63], v[32:35], v[16:19], v[48:63]
    s_mul_i32 s22, s3, 4096
    s_add_u32 s22, s22, 32768
    s_mov_b32 m0, s22
    s_nop 0
    buffer_load_dwordx4 v8, s[28:31], s44 offen lds
    v_mfma_f32_32x32x16_bf16 v[64:79], v[36:39], v[16:19], v[64:79]
    v_mfma_f32_32x32x16_bf16 v[80:95], v[32:35], v[20:23], v[80:95]
    s_mul_i32 s22, s3, 4096
    s_add_u32 s22, s22, 33792
    s_mov_b32 m0, s22
    s_nop 0
    buffer_load_dwordx4 v9, s[28:31], s44 offen lds
    v_mfma_f32_32x32x16_bf16 v[96:111], v[36:39], v[20:23], v[96:111]
    ds_read_b128 v[16:19], v4 offset:0
    ds_read_b128 v[20:23], v4 offset:4096
    ds_read_b64_tr_b16 v[32:33], v6 offset:8192
    ds_read_b64_tr_b16 v[34:35], v6 offset:9216
    ds_read_b64_tr_b16 v[36:37], v7 offset:8192
    ds_read_b64_tr_b16 v[38:39], v7 offset:9216
    s_waitcnt lgkmcnt(6)
    v_mfma_f32_32x32x16_bf16 v[48:63], v[40:43], v[24:27], v[48:63]
    s_mul_i32 s22, s3, 4096
    s_add_u32 s22, s22, 34816
    s_mov_b32 m0, s22
    s_nop 0
    buffer_load_dwordx4 v10, s[28:31], s44 offen lds
    v_mfma_f32_32x32x16_bf16 v[64:79], v[44:47], v[24:27], v[64:79]
    v_mfma_f32_32x32x16_bf16 v[80:95], v[40:43], v[28:31], v[80:95]
    s_mul_i32 s22, s3, 4096
    s_add_u32 s22, s22, 35840
    s_mov_b32 m0, s22
    s_nop 0
    buffer_load_dwordx4 v11, s[28:31], s44 offen lds
    v_mfma_f32_32x32x16_bf16 v[96:111], v[44:47], v[28:31], v[96:111]
    ds_read_b128 v[24:27], v5 offset:0
    ds_read_b128 v[28:31], v5 offset:4096
    ds_read_b64_tr_b16 v[40:41], v6 offset:12288
    ds_read_b64_tr_b16 v[42:43], v6 offset:13312
    ds_read_b64_tr_b16 v[44:45], v7 offset:12288
    ds_read_b64_tr_b16 v[46:47], v7 offset:13312
    s_waitcnt lgkmcnt(6)
    v_mfma_f32_32x32x16_bf16 v[48:63], v[32:35], v[16:19], v[48:63]
    s_mul_i32 s22, s3, 4096
    s_add_u32 s22, s22, 49152
    s_mov_b32 m0, s22
    s_nop 0
    buffer_load_dwordx4 v12, s[32:35], s45 offen lds
    v_mfma_f32_32x32x16_bf16 v[64:79], v[36:39], v[16:19], v[64:79]
    v_mfma_f32_32x32x16_bf16 v[80:95], v[32:35], v[20:23], v[80:95]
    s_mul_i32 s22, s3, 4096
    s_add_u32 s22, s22, 50176
    s_mov_b32 m0, s22
    s_nop 0
    buffer_load_dwordx4 v13, s[32:35], s45 offen lds
    v_mfma_f32_32x32x16_bf16 v[96:111], v[36:39], v[20:23], v[96:111]
    s_waitcnt lgkmcnt(0)
    v_mfma_f32_32x32x16_bf16 v[48:63], v[40:43], v[24:27], v[48:63]
    s_mul_i32 s22, s3, 4096
    s_add_u32 s22, s22, 51200
    s_mov_b32 m0, s22
    s_nop 0
    buffer_load_dwordx4 v14, s[32:35], s45 offen lds
    v_mfma_f32_32x32x16_bf16 v[64:79], v[44:47], v[24:27], v[64:79]
    v_mfma_f32_32x32x16_bf16 v[80:95], v[40:43], v[28:31], v[80:95]
    s_mul_i32 s22, s3, 4096
    s_add_u32 s22, s22, 52224
    s_mov_b32 m0, s22
    s_nop 0
    buffer_load_dwordx4 v15, s[32:35], s45 offen lds
    v_mfma_f32_32x32x16_bf16 v[96:111], v[44:47], v[28:31], v[96:111]
    s_add_u32 s44, s44, 128
    s_add_u32 s45, s45, 786432
    s_waitcnt vmcnt(0)
    s_barrier
    ds_read_b128 v[16:19], v2 offset:32768
    ds_read_b128 v[20:23], v2 offset:36864
    ds_read_b64_tr_b16 v[32:33], v6 offset:32768
    ds_read_b64_tr_b16 v[34:35], v6 offset:33792
    ds_read_b64_tr_b16 v[36:37], v7 offset:32768
    ds_read_b64_tr_b16 v[38:39], v7 offset:33792
    ds_read_b128 v[24:27], v3 offset:32768
    ds_read_b128 v[28:31], v3 offset:36864
    ds_read_b64_tr_b16 v[40:41], v6 offset:36864
    ds_read_b64_tr_b16 v[42:43], v6 offset:37888
    ds_read_b64_tr_b16 v[44:45], v7 offset:36864
    ds_read_b64_tr_b16 v[46:47], v7 offset:37888
    s_waitcnt lgkmcnt(6)
    v_mfma_f32_32x32x16_bf16 v[48:63], v[32:35], v[16:19], v[48:63]
    s_mul_i32 s22, s3, 4096
    s_add_u32 s22, s22, 0
    s_mov_b32 m0, s22
    s_nop 0
    buffer_load_dwordx4 v8, s[28:31], s44 offen lds
    v_mfma_f32_32x32x16_bf16 v[64:79], v[36:39], v[16:19], v[64:79]
    v_mfma_f32_32x32x16_bf16 v[80:95], v[32:35], v[20:23], v[80:95]
    s_mul_i32 s22, s3, 4096
    s_add_u32 s22, s22, 1024
    s_mov_b32 m0, s22
    s_nop 0
    buffer_load_dwordx4 v9, s[28:31], s44 offen lds
    v_mfma_f32_32x32x16_bf16 v[96:111], v[36:39], v[20:23], v[96:111]
    ds_read_b128 v[16:19], v4 offset:32768
    ds_read_b128 v[20:23], v4 offset:36864
    ds_read_b64_tr_b16 v[32:33], v6 offset:40960
    ds_read_b64_tr_b16 v[34:35], v6 offset:41984
    ds_read_b64_tr_b16 v[36:37], v7 offset:40960
    ds_read_b64_tr_b16 v[38:39], v7 offset:41984
    s_waitcnt lgkmcnt(6)
    v_mfma_f32_32x32x16_bf16 v[48:63], v[40:43], v[24:27], v[48:63]
    s_mul_i32 s22, s3, 4096
    s_add_u32 s22, s22, 2048
    s_mov_b32 m0, s22
    s_nop 0
    buffer_load_dwordx4 v10, s[28:31], s44 offen lds
    v_mfma_f32_32x32x16_bf16 v[64:79], v[44:47], v[24:27], v[64:79]
    v_mfma_f32_32x32x16_bf16 v[80:95], v[40:43], v[28:31], v[80:95]
    s_mul_i32 s22, s3, 4096
    s_add_u32 s22, s22, 3072
    s_mov_b32 m0, s22
    s_nop 0
    buffer_load_dwordx4 v11, s[28:31], s44 offen lds
    v_mfma_f32_32x32x16_bf16 v[96:111], v[44:47], v[28:31], v[96:111]
    ds_read_b128 v[24:27], v5 offset:32768
    ds_read_b128 v[28:31], v5 offset:36864
    ds_read_b64_tr_b16 v[40:41], v6 offset:45056
    ds_read_b64_tr_b16 v[42:43], v6 offset:46080
    ds_read_b64_tr_b16 v[44:45], v7 offset:45056
    ds_read_b64_tr_b16 v[46:47], v7 offset:46080
    s_waitcnt lgkmcnt(6)
    v_mfma_f32_32x32x16_bf16 v[48:63], v[32:35], v[16:19], v[48:63]
    s_mul_i32 s22, s3, 4096
    s_add_u32 s22, s22, 16384
    s_mov_b32 m0, s22
    s_nop 0
    buffer_load_dwordx4 v12, s[32:35], s45 offen lds
    v_mfma_f32_32x32x16_bf16 v[64:79], v[36:39], v[16:19], v[64:79]
    v_mfma_f32_32x32x16_bf16 v[80:95], v[32:35], v[20:23], v[80:95]
    s_mul_i32 s22, s3, 4096
    s_add_u32 s22, s22, 17408
    s_mov_b32 m0, s22
    s_nop 0
    buffer_load_dwordx4 v13, s[32:35], s45 offen lds
    v_mfma_f32_32x32x16_bf16 v[96:111], v[36:39], v[20:23], v[96:111]
    s_waitcnt lgkmcnt(0)
    v_mfma_f32_32x32x16_bf16 v[48:63], v[40:43], v[24:27], v[48:63]
    s_mul_i32 s22, s3, 4096
    s_add_u32 s22, s22, 18432
    s_mov_b32 m0, s22
    s_nop 0
    buffer_load_dwordx4 v14, s[32:35], s45 offen lds
    v_mfma_f32_32x32x16_bf16 v[64:79], v[44:47], v[24:27], v[64:79]
    v_mfma_f32_32x32x16_bf16 v[80:95], v[40:43], v[28:31], v[80:95]
    s_mul_i32 s22, s3, 4096
    s_add_u32 s22, s22, 19456
    s_mov_b32 m0, s22
    s_nop 0
    buffer_load_dwordx4 v15, s[32:35], s45 offen lds
    v_mfma_f32_32x32x16_bf16 v[96:111], v[44:47], v[28:31], v[96:111]
    s_add_u32 s44, s44, 128
    s_add_u32 s45, s45, 786432
    s_add_u32 s23, s23, 2
    s_cmp_lt_u32 s23, 10
    s_cbranch_scc1 L_projq_loop
    s_waitcnt vmcnt(0)
    s_barrier
    s_branch L_proj_epi
L_proj_loop2:
    s_mul_i32 s22, s3, 4096
    s_add_u32 s22, s22, 0
    s_mov_b32 m0, s22
    s_add_u32 s22, s22, 1024
    buffer_load_dwordx4 v8, s[28:31], s44 offen lds
    s_mov_b32 m0, s22
    s_add_u32 s22, s22, 1024
    buffer_load_dwordx4 v9, s[28:31], s44 offen lds
    s_mov_b32 m0, s22
    s_add_u32 s22, s22, 1024
    buffer_load_dwordx4 v10, s[28:31], s44 offen lds
    s_mov_b32 m0, s22
    s_add_u32 s22, s22, 1024
    buffer_load_dwordx4 v11, s[28:31], s44 offen lds
    s_mul_i32 s22, s3, 4096
    s_add_u32 s22, s22, 16384
    s_mov_b32 m0, s22
    s_add_u32 s22, s22, 1024
    buffer_load_dwordx4 v12, s[32:35], s45 offen lds
    s_mov_b32 m0, s22
    s_add_u32 s22, s22, 1024
    buffer_load_dwordx4 v13, s[32:35], s45 offen lds
    s_mov_b32 m0, s22
    s_add_u32 s22, s22, 1024
    buffer_load_dwordx4 v14, s[32:35], s45 offen lds
    s_mov_b32 m0, s22
    s_add_u32 s22, s22, 1024
    buffer_load_dwordx4 v15, s[32:35], s45 offen lds
    s_add_u32 s44, s44, 128
    s_add_u32 s45, s45, 196608
    s_mov_b32 s23, 0
L_projh_loop:
    s_waitcnt vmcnt(0)
    s_barrier
    ds_read_b128 v[16:19], v2 offset:0
    ds_read_b128 v[20:23], v2 offset:4096
    ds_read_b64_tr_b16 v[32:33], v6 offset:0
    ds_read_b64_tr_b16 v[34:35], v6 offset:1024
    ds_read_b64_tr_b16 v[36:37], v7 offset:0
    ds_read_b64_tr_b16 v[38:39], v7 offset:1024
    ds_read_b128 v[24:27], v3 offset:0
    ds_read_b128 v[28:31], v3 offset:4096
    ds_read_b64_tr_b16 v[40:41], v6 offset:4096
    ds_read_b64_tr_b16 v[42:43], v6 offset:5120
    ds_read_b64_tr_b16 v[44:45], v7 offset:4096
    ds_read_b64_tr_b16 v[46:47], v7 offset:5120
    s_waitcnt lgkmcnt(6)
    v_mfma_f32_32x32x16_bf16 v[48:63], v[32:35], v[16:19], v[48:63]
    s_mul_i32 s22, s3, 4096
    s_add_u32 s22, s22, 32768
    s_mov_b32 m0, s22
    s_nop 0
    buffer_load_dwordx4 v8, s[28:31], s44 offen lds
    v_mfma_f32_32x32x16_bf16 v[64:79], v[36:39], v[16:19], v[64:79]
    v_mfma_f32_32x32x16_bf16 v[80:95], v[32:35], v[20:23], v[80:95]
    s_mul_i32 s22, s3, 4096
    s_add_u32 s22, s22, 33792
    s_mov_b32 m0, s22
    s_nop 0
    buffer_load_dwordx4 v9, s[28:31], s44 offen lds
    v_mfma_f32_32x32x16_bf16 v[96:111], v[36:39], v[20:23], v[96:111]
    ds_read_b128 v[16:19], v4 offset:0
    ds_read_b128 v[20:23], v4 offset:4096
    ds_read_b64_tr_b16 v[32:33], v6 offset:8192
    ds_read_b64_tr_b16 v[34:35], v6 offset:9216
    ds_read_b64_tr_b16 v[36:37], v7 offset:8192
    ds_read_b64_tr_b16 v[38:39], v7 offset:9216
    s_waitcnt lgkmcnt(6)
    v_mfma_f32_32x32x16_bf16 v[48:63], v[40:43], v[24:27], v[48:63]
    s_mul_i32 s22, s3, 4096
    s_add_u32 s22, s22, 34816
    s_mov_b32 m0, s22
    s_nop 0
    buffer_load_dwordx4 v10, s[28:31], s44 offen lds
    v_mfma_f32_32x32x16_bf16 v[64:79], v[44:47], v[24:27], v[64:79]
    v_mfma_f32_32x32x16_bf16 v[80:95], v[40:43], v[28:31], v[80:95]
    s_mul_i32 s22, s3, 4096
    s_add_u32 s22, s22, 35840
    s_mov_b32 m0, s22
    s_nop 0
    buffer_load_dwordx4 v11, s[28:31], s44 offen lds
    v_mfma_f32_32x32x16_bf16 v[96:111], v[44:47], v[28:31], v[96:111]
    ds_read_b128 v[24:27], v5 offset:0
    ds_read_b128 v[28:31], v5 offset:4096
    ds_read_b64_tr_b16 v[40:41], v6 offset:12288
    ds_read_b64_tr_b16 v[42:43], v6 offset:13312
    ds_read_b64_tr_b16 v[44:45], v7 offset:12288
    ds_read_b64_tr_b16 v[46:47], v7 offset:13312
    s_waitcnt lgkmcnt(6)
    v_mfma_f32_32x32x16_bf16 v[48:63], v[32:35], v[16:19], v[48:63]
    s_mul_i32 s22, s3, 4096
    s_add_u32 s22, s22, 49152
    s_mov_b32 m0, s22
    s_nop 0
    buffer_load_dwordx4 v12, s[32:35], s45 offen lds
    v_mfma_f32_32x32x16_bf16 v[64:79], v[36:39], v[16:19], v[64:79]
    v_mfma_f32_32x32x16_bf16 v[80:95], v[32:35], v[20:23], v[80:95]
    s_mul_i32 s22, s3, 4096
    s_add_u32 s22, s22, 50176
    s_mov_b32 m0, s22
    s_nop 0
    buffer_load_dwordx4 v13, s[32:35], s45 offen lds
    v_mfma_f32_32x32x16_bf16 v[96:111], v[36:39], v[20:23], v[96:111]
    s_waitcnt lgkmcnt(0)
    v_mfma_f32_32x32x16_bf16 v[48:63], v[40:43], v[24:27], v[48:63]
    s_mul_i32 s22, s3, 4096
    s_add_u32 s22, s22, 51200
    s_mov_b32 m0, s22
    s_nop 0
    buffer_load_dwordx4 v14, s[32:35], s45 offen lds
    v_mfma_f32_32x32x16_bf16 v[64:79], v[44:47], v[24:27], v[64:79]
    v_mfma_f32_32x32x16_bf16 v[80:95], v[40:43], v[28:31], v[80:95]
    s_mul_i32 s22, s3, 4096
    s_add_u32 s22, s22, 52224
    s_mov_b32 m0, s22
    s_nop 0
    buffer_load_dwordx4 v15, s[32:35], s45 offen lds
    v_mfma_f32_32x32x16_bf16 v[96:111], v[44:47], v[28:31], v[96:111]
    s_add_u32 s44, s44, 128
    s_add_u32 s45, s45, 196608
    s_waitcnt vmcnt(0)
    s_barrier
    ds_read_b128 v[16:19], v2 offset:32768
    ds_read_b128 v[20:23], v2 offset:36864
    ds_read_b64_tr_b16 v[32:33], v6 offset:32768
    ds_read_b64_tr_b16 v[34:35], v6 offset:33792
    ds_read_b64_tr_b16 v[36:37], v7 offset:32768
    ds_read_b64_tr_b16 v[38:39], v7 offset:33792
    ds_read_b128 v[24:27], v3 offset:32768
    ds_read_b128 v[28:31], v3 offset:36864
    ds_read_b64_tr_b16 v[40:41], v6 offset:36864
    ds_read_b64_tr_b16 v[42:43], v6 offset:37888
    ds_read_b64_tr_b16 v[44:45], v7 offset:36864
    ds_read_b64_tr_b16 v[46:47], v7 offset:37888
    s_waitcnt lgkmcnt(6)
    v_mfma_f32_32x32x16_bf16 v[48:63], v[32:35], v[16:19], v[48:63]
    s_mul_i32 s22, s3, 4096
    s_add_u32 s22, s22, 0
    s_mov_b32 m0, s22
    s_nop 0
    buffer_load_dwordx4 v8, s[28:31], s44 offen lds
    v_mfma_f32_32x32x16_bf16 v[64:79], v[36:39], v[16:19], v[64:79]
    v_mfma_f32_32x32x16_bf16 v[80:95], v[32:35], v[20:23], v[80:95]
    s_mul_i32 s22, s3, 4096
    s_add_u32 s22, s22, 1024
    s_mov_b32 m0, s22
    s_nop 0
    buffer_load_dwordx4 v9, s[28:31], s44 offen lds
    v_mfma_f32_32x32x16_bf16 v[96:111], v[36:39], v[20:23], v[96:111]
    ds_read_b128 v[16:19], v4 offset:32768
    ds_read_b128 v[20:23], v4 offset:36864
    ds_read_b64_tr_b16 v[32:33], v6 offset:40960
    ds_read_b64_tr_b16 v[34:35], v6 offset:41984
    ds_read_b64_tr_b16 v[36:37], v7 offset:40960
    ds_read_b64_tr_b16 v[38:39], v7 offset:41984
    s_waitcnt lgkmcnt(6)
    v_mfma_f32_32x32x16_bf16 v[48:63], v[40:43], v[24:27], v[48:63]
    s_mul_i32 s22, s3, 4096
    s_add_u32 s22, s22, 2048
    s_mov_b32 m0, s22
    s_nop 0
    buffer_load_dwordx4 v10, s[28:31], s44 offen lds
    v_mfma_f32_32x32x16_bf16 v[64:79], v[44:47], v[24:27], v[64:79]
    v_mfma_f32_32x32x16_bf16 v[80:95], v[40:43], v[28:31], v[80:95]
    s_mul_i32 s22, s3, 4096
    s_add_u32 s22, s22, 3072
    s_mov_b32 m0, s22
    s_nop 0
    buffer_load_dwordx4 v11, s[28:31], s44 offen lds
    v_mfma_f32_32x32x16_bf16 v[96:111], v[44:47], v[28:31], v[96:111]
    ds_read_b128 v[24:27], v5 offset:32768
    ds_read_b128 v[28:31], v5 offset:36864
    ds_read_b64_tr_b16 v[40:41], v6 offset:45056
    ds_read_b64_tr_b16 v[42:43], v6 offset:46080
    ds_read_b64_tr_b16 v[44:45], v7 offset:45056
    ds_read_b64_tr_b16 v[46:47], v7 offset:46080
    s_waitcnt lgkmcnt(6)
    v_mfma_f32_32x32x16_bf16 v[48:63], v[32:35], v[16:19], v[48:63]
    s_mul_i32 s22, s3, 4096
    s_add_u32 s22, s22, 16384
    s_mov_b32 m0, s22
    s_nop 0
    buffer_load_dwordx4 v12, s[32:35], s45 offen lds
    v_mfma_f32_32x32x16_bf16 v[64:79], v[36:39], v[16:19], v[64:79]
    v_mfma_f32_32x32x16_bf16 v[80:95], v[32:35], v[20:23], v[80:95]
    s_mul_i32 s22, s3, 4096
    s_add_u32 s22, s22, 17408
    s_mov_b32 m0, s22
    s_nop 0
    buffer_load_dwordx4 v13, s[32:35], s45 offen lds
    v_mfma_f32_32x32x16_bf16 v[96:111], v[36:39], v[20:23], v[96:111]
    s_waitcnt lgkmcnt(0)
    v_mfma_f32_32x32x16_bf16 v[48:63], v[40:43], v[24:27], v[48:63]
    s_mul_i32 s22, s3, 4096
    s_add_u32 s22, s22, 18432
    s_mov_b32 m0, s22
    s_nop 0
    buffer_load_dwordx4 v14, s[32:35], s45 offen lds
    v_mfma_f32_32x32x16_bf16 v[64:79], v[44:47], v[24:27], v[64:79]
    v_mfma_f32_32x32x16_bf16 v[80:95], v[40:43], v[28:31], v[80:95]
    s_mul_i32 s22, s3, 4096
    s_add_u32 s22, s22, 19456
    s_mov_b32 m0, s22
    s_nop 0
    buffer_load_dwordx4 v15, s[32:35], s45 offen lds
    v_mfma_f32_32x32x16_bf16 v[96:111], v[44:47], v[28:31], v[96:111]
    s_add_u32 s44, s44, 128
    s_add_u32 s45, s45, 196608
    s_add_u32 s23, s23, 2
    s_cmp_lt_u32 s23, 10
    s_cbranch_scc1 L_projh_loop
    s_waitcnt vmcnt(0)
    s_barrier
L_proj_epi:
    s_nop 7
    s_nop 7
    v_and_b32 v112, 31, v0
    v_bfe_u32 v113, v0, 5, 1
    s_lshl_b32 s22, s24, 7
    s_lshl_b32 s46, s20, 6
    s_add_u32 s22, s22, s46
    v_add_u32 v112, s22, v112
    v_mul_lo_u32 v112, v112, s26
    s_lshl_b32 s22, s25, 7
    s_lshl_b32 s46, s21, 6
    s_add_u32 s22, s22, s46
    v_lshlrev_b32 v113, 2, v113
    v_add_u32 v113, s22, v113
    v_lshlrev_b32 v113, 1, v113
    v_add_u32 v112, v112, v113
    s_lshl_b32 s47, s26, 5
    s_cmp_eq_u32 s26, 12288
    s_cbranch_scc0 L_proj_epi_h
    v_cvt_pk_bf16_f32 v116, v48, v49
    v_cvt_pk_bf16_f32 v117, v50, v51
    buffer_store_dwordx2 v[116:117], v112, s[36:39], 0 offen offset:0
    s_nop 1
    v_cvt_pk_bf16_f32 v116, v52, v53
    v_cvt_pk_bf16_f32 v117, v54, v55
    buffer_store_dwordx2 v[116:117], v112, s[36:39], 0 offen offset:16
    s_nop 1
    v_cvt_pk_bf16_f32 v116, v56, v57
    v_cvt_pk_bf16_f32 v117, v58, v59
    buffer_store_dwordx2 v[116:117], v112, s[36:39], 0 offen offset:32
    s_nop 1
    v_cvt_pk_bf16_f32 v116, v60, v61
    v_cvt_pk_bf16_f32 v117, v62, v63
    buffer_store_dwordx2 v[116:117], v112, s[36:39], 0 offen offset:48
    s_nop 1
    v_cvt_pk_bf16_f32 v116, v64, v65
    v_cvt_pk_bf16_f32 v117, v66, v67
    buffer_store_dwordx2 v[116:117], v112, s[36:39], 0 offen offset:64
    s_nop 1
    v_cvt_pk_bf16_f32 v116, v68, v69
    v_cvt_pk_bf16_f32 v117, v70, v71
    buffer_store_dwordx2 v[116:117], v112, s[36:39], 0 offen offset:80
    s_nop 1
    v_cvt_pk_bf16_f32 v116, v72, v73
    v_cvt_pk_bf16_f32 v117, v74, v75
    buffer_store_dwordx2 v[116:117], v112, s[36:39], 0 offen offset:96
    s_nop 1
    v_cvt_pk_bf16_f32 v116, v76, v77
    v_cvt_pk_bf16_f32 v117, v78, v79
    buffer_store_dwordx2 v[116:117], v112, s[36:39], 0 offen offset:112
    s_nop 1
    v_cvt_pk_bf16_f32 v116, v80, v81
    v_cvt_pk_bf16_f32 v117, v82, v83
    buffer_store_dwordx2 v[116:117], v112, s[36:39], s47 offen offset:0
    s_nop 1
    v_cvt_pk_bf16_f32 v116, v84, v85
    v_cvt_pk_bf16_f32 v117, v86, v87
    buffer_store_dwordx2 v[116:117], v112, s[36:39], s47 offen offset:16
    s_nop 1
    v_cvt_pk_bf16_f32 v116, v88, v89
    v_cvt_pk_bf16_f32 v117, v90, v91
    buffer_store_dwordx2 v[116:117], v112, s[36:39], s47 offen offset:32
    s_nop 1
    v_cvt_pk_bf16_f32 v116, v92, v93
    v_cvt_pk_bf16_f32 v117, v94, v95
    buffer_store_dwordx2 v[116:117], v112, s[36:39], s47 offen offset:48
    s_nop 1
    v_cvt_pk_bf16_f32 v116, v96, v97
    v_cvt_pk_bf16_f32 v117, v98, v99
    buffer_store_dwordx2 v[116:117], v112, s[36:39], s47 offen offset:64
    s_nop 1
    v_cvt_pk_bf16_f32 v116, v100, v101
    v_cvt_pk_bf16_f32 v117, v102, v103
    buffer_store_dwordx2 v[116:117], v112, s[36:39], s47 offen offset:80
    s_nop 1
    v_cvt_pk_bf16_f32 v116, v104, v105
    v_cvt_pk_bf16_f32 v117, v106, v107
    buffer_store_dwordx2 v[116:117], v112, s[36:39], s47 offen offset:96
    s_nop 1
    v_cvt_pk_bf16_f32 v116, v108, v109
    v_cvt_pk_bf16_f32 v117, v110, v111
    buffer_store_dwordx2 v[116:117], v112, s[36:39], s47 offen offset:112
    s_nop 1
    s_branch L_proj_done
L_proj_epi_h:
    s_mov_b32 s48, 0x3d372713
    s_mov_b32 s49, 0x40135761
    buffer_load_dwordx2 v[120:121], v113, s[40:43], 0 offen offset:0
    buffer_load_dwordx2 v[122:123], v113, s[40:43], 0 offen offset:16
    buffer_load_dwordx2 v[124:125], v113, s[40:43], 0 offen offset:32
    buffer_load_dwordx2 v[126:127], v113, s[40:43], 0 offen offset:48
    buffer_load_dwordx2 v[128:129], v113, s[40:43], 0 offen offset:64
    buffer_load_dwordx2 v[130:131], v113, s[40:43], 0 offen offset:80
    buffer_load_dwordx2 v[132:133], v113, s[40:43], 0 offen offset:96
    buffer_load_dwordx2 v[134:135], v113, s[40:43], 0 offen offset:112
    s_waitcnt vmcnt(0)
    v_cvt_pk_bf16_f32 v116, v48, v49
    v_lshlrev_b32 v48, 16, v116
    v_and_b32 v49, 0xffff0000, v116
    v_lshlrev_b32 v117, 16, v120
    v_and_b32 v118, 0xffff0000, v120
    v_add_f32 v48, v48, v117
    v_add_f32 v49, v49, v118
    v_cvt_pk_bf16_f32 v116, v48, v49
    v_lshlrev_b32 v48, 16, v116
    v_and_b32 v49, 0xffff0000, v116
    v_mul_f32 v117, v48, v48
    v_fma_f32 v117, v117, s48, 1.0
    v_mul_f32 v117, v117, v48
    v_mul_f32 v117, s49, v117
    v_exp_f32 v118, -v117
    s_nop 0
    v_add_f32 v118, 1.0, v118
    v_rcp_f32 v118, v118
    s_nop 0
    v_mul_f32 v48, v48, v118
    v_mul_f32 v117, v49, v49
    v_fma_f32 v117, v117, s48, 1.0
    v_mul_f32 v117, v117, v49
    v_mul_f32 v117, s49, v117
    v_exp_f32 v118, -v117
    s_nop 0
    v_add_f32 v118, 1.0, v118
    v_rcp_f32 v118, v118
    s_nop 0
    v_mul_f32 v49, v49, v118
    v_cvt_pk_bf16_f32 v116, v50, v51
    v_lshlrev_b32 v50, 16, v116
    v_and_b32 v51, 0xffff0000, v116
    v_lshlrev_b32 v117, 16, v121
    v_and_b32 v118, 0xffff0000, v121
    v_add_f32 v50, v50, v117
    v_add_f32 v51, v51, v118
    v_cvt_pk_bf16_f32 v116, v50, v51
    v_lshlrev_b32 v50, 16, v116
    v_and_b32 v51, 0xffff0000, v116
    v_mul_f32 v117, v50, v50
    v_fma_f32 v117, v117, s48, 1.0
    v_mul_f32 v117, v117, v50
    v_mul_f32 v117, s49, v117
    v_exp_f32 v118, -v117
    s_nop 0
    v_add_f32 v118, 1.0, v118
    v_rcp_f32 v118, v118
    s_nop 0
    v_mul_f32 v50, v50, v118
    v_mul_f32 v117, v51, v51
    v_fma_f32 v117, v117, s48, 1.0
    v_mul_f32 v117, v117, v51
    v_mul_f32 v117, s49, v117
    v_exp_f32 v118, -v117
    s_nop 0
    v_add_f32 v118, 1.0, v118
    v_rcp_f32 v118, v118
    s_nop 0
    v_mul_f32 v51, v51, v118
    v_cvt_pk_bf16_f32 v116, v48, v49
    v_cvt_pk_bf16_f32 v117, v50, v51
    buffer_store_dwordx2 v[116:117], v112, s[36:39], 0 offen offset:0
    s_nop 1
    v_cvt_pk_bf16_f32 v116, v52, v53
    v_lshlrev_b32 v52, 16, v116
    v_and_b32 v53, 0xffff0000, v116
    v_lshlrev_b32 v117, 16, v122
    v_and_b32 v118, 0xffff0000, v122
    v_add_f32 v52, v52, v117
    v_add_f32 v53, v53, v118
    v_cvt_pk_bf16_f32 v116, v52, v53
    v_lshlrev_b32 v52, 16, v116
    v_and_b32 v53, 0xffff0000, v116
    v_mul_f32 v117, v52, v52
    v_fma_f32 v117, v117, s48, 1.0
    v_mul_f32 v117, v117, v52
    v_mul_f32 v117, s49, v117
    v_exp_f32 v118, -v117
    s_nop 0
    v_add_f32 v118, 1.0, v118
    v_rcp_f32 v118, v118
    s_nop 0
    v_mul_f32 v52, v52, v118
    v_mul_f32 v117, v53, v53
    v_fma_f32 v117, v117, s48, 1.0
    v_mul_f32 v117, v117, v53
    v_mul_f32 v117, s49, v117
    v_exp_f32 v118, -v117
    s_nop 0
    v_add_f32 v118, 1.0, v118
    v_rcp_f32 v118, v118
    s_nop 0
    v_mul_f32 v53, v53, v118
    v_cvt_pk_bf16_f32 v116, v54, v55
    v_lshlrev_b32 v54, 16, v116
    v_and_b32 v55, 0xffff0000, v116
    v_lshlrev_b32 v117, 16, v123
    v_and_b32 v118, 0xffff0000, v123
    v_add_f32 v54, v54, v117
    v_add_f32 v55, v55, v118
    v_cvt_pk_bf16_f32 v116, v54, v55
    v_lshlrev_b32 v54, 16, v116
    v_and_b32 v55, 0xffff0000, v116
    v_mul_f32 v117, v54, v54
    v_fma_f32 v117, v117, s48, 1.0
    v_mul_f32 v117, v117, v54
    v_mul_f32 v117, s49, v117
    v_exp_f32 v118, -v117
    s_nop 0
    v_add_f32 v118, 1.0, v118
    v_rcp_f32 v118, v118
    s_nop 0
    v_mul_f32 v54, v54, v118
    v_mul_f32 v117, v55, v55
    v_fma_f32 v117, v117, s48, 1.0
    v_mul_f32 v117, v117, v55
    v_mul_f32 v117, s49, v117
    v_exp_f32 v118, -v117
    s_nop 0
    v_add_f32 v118, 1.0, v118
    v_rcp_f32 v118, v118
    s_nop 0
    v_mul_f32 v55, v55, v118
    v_cvt_pk_bf16_f32 v116, v52, v53
    v_cvt_pk_bf16_f32 v117, v54, v55
    buffer_store_dwordx2 v[116:117], v112, s[36:39], 0 offen offset:16
    s_nop 1
    v_cvt_pk_bf16_f32 v116, v56, v57
    v_lshlrev_b32 v56, 16, v116
    v_and_b32 v57, 0xffff0000, v116
    v_lshlrev_b32 v117, 16, v124
    v_and_b32 v118, 0xffff0000, v124
    v_add_f32 v56, v56, v117
    v_add_f32 v57, v57, v118
    v_cvt_pk_bf16_f32 v116, v56, v57
    v_lshlrev_b32 v56, 16, v116
    v_and_b32 v57, 0xffff0000, v116
    v_mul_f32 v117, v56, v56
    v_fma_f32 v117, v117, s48, 1.0
    v_mul_f32 v117, v117, v56
    v_mul_f32 v117, s49, v117
    v_exp_f32 v118, -v117
    s_nop 0
    v_add_f32 v118, 1.0, v118
    v_rcp_f32 v118, v118
    s_nop 0
    v_mul_f32 v56, v56, v118
    v_mul_f32 v117, v57, v57
    v_fma_f32 v117, v117, s48, 1.0
    v_mul_f32 v117, v117, v57
    v_mul_f32 v117, s49, v117
    v_exp_f32 v118, -v117
    s_nop 0
    v_add_f32 v118, 1.0, v118
    v_rcp_f32 v118, v118
    s_nop 0
    v_mul_f32 v57, v57, v118
    v_cvt_pk_bf16_f32 v116, v58, v59
    v_lshlrev_b32 v58, 16, v116
    v_and_b32 v59, 0xffff0000, v116
    v_lshlrev_b32 v117, 16, v125
    v_and_b32 v118, 0xffff0000, v125
    v_add_f32 v58, v58, v117
    v_add_f32 v59, v59, v118
    v_cvt_pk_bf16_f32 v116, v58, v59
    v_lshlrev_b32 v58, 16, v116
    v_and_b32 v59, 0xffff0000, v116
    v_mul_f32 v117, v58, v58
    v_fma_f32 v117, v117, s48, 1.0
    v_mul_f32 v117, v117, v58
    v_mul_f32 v117, s49, v117
    v_exp_f32 v118, -v117
    s_nop 0
    v_add_f32 v118, 1.0, v118
    v_rcp_f32 v118, v118
    s_nop 0
    v_mul_f32 v58, v58, v118
    v_mul_f32 v117, v59, v59
    v_fma_f32 v117, v117, s48, 1.0
    v_mul_f32 v117, v117, v59
    v_mul_f32 v117, s49, v117
    v_exp_f32 v118, -v117
    s_nop 0
    v_add_f32 v118, 1.0, v118
    v_rcp_f32 v118, v118
    s_nop 0
    v_mul_f32 v59, v59, v118
    v_cvt_pk_bf16_f32 v116, v56, v57
    v_cvt_pk_bf16_f32 v117, v58, v59
    buffer_store_dwordx2 v[116:117], v112, s[36:39], 0 offen offset:32
    s_nop 1
    v_cvt_pk_bf16_f32 v116, v60, v61
    v_lshlrev_b32 v60, 16, v116
    v_and_b32 v61, 0xffff0000, v116
    v_lshlrev_b32 v117, 16, v126
    v_and_b32 v118, 0xffff0000, v126
    v_add_f32 v60, v60, v117
    v_add_f32 v61, v61, v118
    v_cvt_pk_bf16_f32 v116, v60, v61
    v_lshlrev_b32 v60, 16, v116
    v_and_b32 v61, 0xffff0000, v116
    v_mul_f32 v117, v60, v60
    v_fma_f32 v117, v117, s48, 1.0
    v_mul_f32 v117, v117, v60
    v_mul_f32 v117, s49, v117
    v_exp_f32 v118, -v117
    s_nop 0
    v_add_f32 v118, 1.0, v118
    v_rcp_f32 v118, v118
    s_nop 0
    v_mul_f32 v60, v60, v118
    v_mul_f32 v117, v61, v61
    v_fma_f32 v117, v117, s48, 1.0
    v_mul_f32 v117, v117, v61
    v_mul_f32 v117, s49, v117
    v_exp_f32 v118, -v117
    s_nop 0
    v_add_f32 v118, 1.0, v118
    v_rcp_f32 v118, v118
    s_nop 0
    v_mul_f32 v61, v61, v118
    v_cvt_pk_bf16_f32 v116, v62, v63
    v_lshlrev_b32 v62, 16, v116
    v_and_b32 v63, 0xffff0000, v116
    v_lshlrev_b32 v117, 16, v127
    v_and_b32 v118, 0xffff0000, v127
    v_add_f32 v62, v62, v117
    v_add_f32 v63, v63, v118
    v_cvt_pk_bf16_f32 v116, v62, v63
    v_lshlrev_b32 v62, 16, v116
    v_and_b32 v63, 0xffff0000, v116
    v_mul_f32 v117, v62, v62
    v_fma_f32 v117, v117, s48, 1.0
    v_mul_f32 v117, v117, v62
    v_mul_f32 v117, s49, v117
    v_exp_f32 v118, -v117
    s_nop 0
    v_add_f32 v118, 1.0, v118
    v_rcp_f32 v118, v118
    s_nop 0
    v_mul_f32 v62, v62, v118
    v_mul_f32 v117, v63, v63
    v_fma_f32 v117, v117, s48, 1.0
    v_mul_f32 v117, v117, v63
    v_mul_f32 v117, s49, v117
    v_exp_f32 v118, -v117
    s_nop 0
    v_add_f32 v118, 1.0, v118
    v_rcp_f32 v118, v118
    s_nop 0
    v_mul_f32 v63, v63, v118
    v_cvt_pk_bf16_f32 v116, v60, v61
    v_cvt_pk_bf16_f32 v117, v62, v63
    buffer_store_dwordx2 v[116:117], v112, s[36:39], 0 offen offset:48
    s_nop 1
    v_cvt_pk_bf16_f32 v116, v64, v65
    v_lshlrev_b32 v64, 16, v116
    v_and_b32 v65, 0xffff0000, v116
    v_lshlrev_b32 v117, 16, v128
    v_and_b32 v118, 0xffff0000, v128
    v_add_f32 v64, v64, v117
    v_add_f32 v65, v65, v118
    v_cvt_pk_bf16_f32 v116, v64, v65
    v_lshlrev_b32 v64, 16, v116
    v_and_b32 v65, 0xffff0000, v116
    v_mul_f32 v117, v64, v64
    v_fma_f32 v117, v117, s48, 1.0
    v_mul_f32 v117, v117, v64
    v_mul_f32 v117, s49, v117
    v_exp_f32 v118, -v117
    s_nop 0
    v_add_f32 v118, 1.0, v118
    v_rcp_f32 v118, v118
    s_nop 0
    v_mul_f32 v64, v64, v118
    v_mul_f32 v117, v65, v65
    v_fma_f32 v117, v117, s48, 1.0
    v_mul_f32 v117, v117, v65
    v_mul_f32 v117, s49, v117
    v_exp_f32 v118, -v117
    s_nop 0
    v_add_f32 v118, 1.0, v118
    v_rcp_f32 v118, v118
    s_nop 0
    v_mul_f32 v65, v65, v118
    v_cvt_pk_bf16_f32 v116, v66, v67
    v_lshlrev_b32 v66, 16, v116
    v_and_b32 v67, 0xffff0000, v116
    v_lshlrev_b32 v117, 16, v129
    v_and_b32 v118, 0xffff0000, v129
    v_add_f32 v66, v66, v117
    v_add_f32 v67, v67, v118
    v_cvt_pk_bf16_f32 v116, v66, v67
    v_lshlrev_b32 v66, 16, v116
    v_and_b32 v67, 0xffff0000, v116
    v_mul_f32 v117, v66, v66
    v_fma_f32 v117, v117, s48, 1.0
    v_mul_f32 v117, v117, v66
    v_mul_f32 v117, s49, v117
    v_exp_f32 v118, -v117
    s_nop 0
    v_add_f32 v118, 1.0, v118
    v_rcp_f32 v118, v118
    s_nop 0
    v_mul_f32 v66, v66, v118
    v_mul_f32 v117, v67, v67
    v_fma_f32 v117, v117, s48, 1.0
    v_mul_f32 v117, v117, v67
    v_mul_f32 v117, s49, v117
    v_exp_f32 v118, -v117
    s_nop 0
    v_add_f32 v118, 1.0, v118
    v_rcp_f32 v118, v118
    s_nop 0
    v_mul_f32 v67, v67, v118
    v_cvt_pk_bf16_f32 v116, v64, v65
    v_cvt_pk_bf16_f32 v117, v66, v67
    buffer_store_dwordx2 v[116:117], v112, s[36:39], 0 offen offset:64
    s_nop 1
    v_cvt_pk_bf16_f32 v116, v68, v69
    v_lshlrev_b32 v68, 16, v116
    v_and_b32 v69, 0xffff0000, v116
    v_lshlrev_b32 v117, 16, v130
    v_and_b32 v118, 0xffff0000, v130
    v_add_f32 v68, v68, v117
    v_add_f32 v69, v69, v118
    v_cvt_pk_bf16_f32 v116, v68, v69
    v_lshlrev_b32 v68, 16, v116
    v_and_b32 v69, 0xffff0000, v116
    v_mul_f32 v117, v68, v68
    v_fma_f32 v117, v117, s48, 1.0
    v_mul_f32 v117, v117, v68
    v_mul_f32 v117, s49, v117
    v_exp_f32 v118, -v117
    s_nop 0
    v_add_f32 v118, 1.0, v118
    v_rcp_f32 v118, v118
    s_nop 0
    v_mul_f32 v68, v68, v118
    v_mul_f32 v117, v69, v69
    v_fma_f32 v117, v117, s48, 1.0
    v_mul_f32 v117, v117, v69
    v_mul_f32 v117, s49, v117
    v_exp_f32 v118, -v117
    s_nop 0
    v_add_f32 v118, 1.0, v118
    v_rcp_f32 v118, v118
    s_nop 0
    v_mul_f32 v69, v69, v118
    v_cvt_pk_bf16_f32 v116, v70, v71
    v_lshlrev_b32 v70, 16, v116
    v_and_b32 v71, 0xffff0000, v116
    v_lshlrev_b32 v117, 16, v131
    v_and_b32 v118, 0xffff0000, v131
    v_add_f32 v70, v70, v117
    v_add_f32 v71, v71, v118
    v_cvt_pk_bf16_f32 v116, v70, v71
    v_lshlrev_b32 v70, 16, v116
    v_and_b32 v71, 0xffff0000, v116
    v_mul_f32 v117, v70, v70
    v_fma_f32 v117, v117, s48, 1.0
    v_mul_f32 v117, v117, v70
    v_mul_f32 v117, s49, v117
    v_exp_f32 v118, -v117
    s_nop 0
    v_add_f32 v118, 1.0, v118
    v_rcp_f32 v118, v118
    s_nop 0
    v_mul_f32 v70, v70, v118
    v_mul_f32 v117, v71, v71
    v_fma_f32 v117, v117, s48, 1.0
    v_mul_f32 v117, v117, v71
    v_mul_f32 v117, s49, v117
    v_exp_f32 v118, -v117
    s_nop 0
    v_add_f32 v118, 1.0, v118
    v_rcp_f32 v118, v118
    s_nop 0
    v_mul_f32 v71, v71, v118
    v_cvt_pk_bf16_f32 v116, v68, v69
    v_cvt_pk_bf16_f32 v117, v70, v71
    buffer_store_dwordx2 v[116:117], v112, s[36:39], 0 offen offset:80
    s_nop 1
    v_cvt_pk_bf16_f32 v116, v72, v73
    v_lshlrev_b32 v72, 16, v116
    v_and_b32 v73, 0xffff0000, v116
    v_lshlrev_b32 v117, 16, v132
    v_and_b32 v118, 0xffff0000, v132
    v_add_f32 v72, v72, v117
    v_add_f32 v73, v73, v118
    v_cvt_pk_bf16_f32 v116, v72, v73
    v_lshlrev_b32 v72, 16, v116
    v_and_b32 v73, 0xffff0000, v116
    v_mul_f32 v117, v72, v72
    v_fma_f32 v117, v117, s48, 1.0
    v_mul_f32 v117, v117, v72
    v_mul_f32 v117, s49, v117
    v_exp_f32 v118, -v117
    s_nop 0
    v_add_f32 v118, 1.0, v118
    v_rcp_f32 v118, v118
    s_nop 0
    v_mul_f32 v72, v72, v118
    v_mul_f32 v117, v73, v73
    v_fma_f32 v117, v117, s48, 1.0
    v_mul_f32 v117, v117, v73
    v_mul_f32 v117, s49, v117
    v_exp_f32 v118, -v117
    s_nop 0
    v_add_f32 v118, 1.0, v118
    v_rcp_f32 v118, v118
    s_nop 0
    v_mul_f32 v73, v73, v118
    v_cvt_pk_bf16_f32 v116, v74, v75
    v_lshlrev_b32 v74, 16, v116
    v_and_b32 v75, 0xffff0000, v116
    v_lshlrev_b32 v117, 16, v133
    v_and_b32 v118, 0xffff0000, v133
    v_add_f32 v74, v74, v117
    v_add_f32 v75, v75, v118
    v_cvt_pk_bf16_f32 v116, v74, v75
    v_lshlrev_b32 v74, 16, v116
    v_and_b32 v75, 0xffff0000, v116
    v_mul_f32 v117, v74, v74
    v_fma_f32 v117, v117, s48, 1.0
    v_mul_f32 v117, v117, v74
    v_mul_f32 v117, s49, v117
    v_exp_f32 v118, -v117
    s_nop 0
    v_add_f32 v118, 1.0, v118
    v_rcp_f32 v118, v118
    s_nop 0
    v_mul_f32 v74, v74, v118
    v_mul_f32 v117, v75, v75
    v_fma_f32 v117, v117, s48, 1.0
    v_mul_f32 v117, v117, v75
    v_mul_f32 v117, s49, v117
    v_exp_f32 v118, -v117
    s_nop 0
    v_add_f32 v118, 1.0, v118
    v_rcp_f32 v118, v118
    s_nop 0
    v_mul_f32 v75, v75, v118
    v_cvt_pk_bf16_f32 v116, v72, v73
    v_cvt_pk_bf16_f32 v117, v74, v75
    buffer_store_dwordx2 v[116:117], v112, s[36:39], 0 offen offset:96
    s_nop 1
    v_cvt_pk_bf16_f32 v116, v76, v77
    v_lshlrev_b32 v76, 16, v116
    v_and_b32 v77, 0xffff0000, v116
    v_lshlrev_b32 v117, 16, v134
    v_and_b32 v118, 0xffff0000, v134
    v_add_f32 v76, v76, v117
    v_add_f32 v77, v77, v118
    v_cvt_pk_bf16_f32 v116, v76, v77
    v_lshlrev_b32 v76, 16, v116
    v_and_b32 v77, 0xffff0000, v116
    v_mul_f32 v117, v76, v76
    v_fma_f32 v117, v117, s48, 1.0
    v_mul_f32 v117, v117, v76
    v_mul_f32 v117, s49, v117
    v_exp_f32 v118, -v117
    s_nop 0
    v_add_f32 v118, 1.0, v118
    v_rcp_f32 v118, v118
    s_nop 0
    v_mul_f32 v76, v76, v118
    v_mul_f32 v117, v77, v77
    v_fma_f32 v117, v117, s48, 1.0
    v_mul_f32 v117, v117, v77
    v_mul_f32 v117, s49, v117
    v_exp_f32 v118, -v117
    s_nop 0
    v_add_f32 v118, 1.0, v118
    v_rcp_f32 v118, v118
    s_nop 0
    v_mul_f32 v77, v77, v118
    v_cvt_pk_bf16_f32 v116, v78, v79
    v_lshlrev_b32 v78, 16, v116
    v_and_b32 v79, 0xffff0000, v116
    v_lshlrev_b32 v117, 16, v135
    v_and_b32 v118, 0xffff0000, v135
    v_add_f32 v78, v78, v117
    v_add_f32 v79, v79, v118
    v_cvt_pk_bf16_f32 v116, v78, v79
    v_lshlrev_b32 v78, 16, v116
    v_and_b32 v79, 0xffff0000, v116
    v_mul_f32 v117, v78, v78
    v_fma_f32 v117, v117, s48, 1.0
    v_mul_f32 v117, v117, v78
    v_mul_f32 v117, s49, v117
    v_exp_f32 v118, -v117
    s_nop 0
    v_add_f32 v118, 1.0, v118
    v_rcp_f32 v118, v118
    s_nop 0
    v_mul_f32 v78, v78, v118
    v_mul_f32 v117, v79, v79
    v_fma_f32 v117, v117, s48, 1.0
    v_mul_f32 v117, v117, v79
    v_mul_f32 v117, s49, v117
    v_exp_f32 v118, -v117
    s_nop 0
    v_add_f32 v118, 1.0, v118
    v_rcp_f32 v118, v118
    s_nop 0
    v_mul_f32 v79, v79, v118
    v_cvt_pk_bf16_f32 v116, v76, v77
    v_cvt_pk_bf16_f32 v117, v78, v79
    buffer_store_dwordx2 v[116:117], v112, s[36:39], 0 offen offset:112
    s_nop 1
    v_cvt_pk_bf16_f32 v116, v80, v81
    v_lshlrev_b32 v80, 16, v116
    v_and_b32 v81, 0xffff0000, v116
    v_lshlrev_b32 v117, 16, v120
    v_and_b32 v118, 0xffff0000, v120
    v_add_f32 v80, v80, v117
    v_add_f32 v81, v81, v118
    v_cvt_pk_bf16_f32 v116, v80, v81
    v_lshlrev_b32 v80, 16, v116
    v_and_b32 v81, 0xffff0000, v116
    v_mul_f32 v117, v80, v80
    v_fma_f32 v117, v117, s48, 1.0
    v_mul_f32 v117, v117, v80
    v_mul_f32 v117, s49, v117
    v_exp_f32 v118, -v117
    s_nop 0
    v_add_f32 v118, 1.0, v118
    v_rcp_f32 v118, v118
    s_nop 0
    v_mul_f32 v80, v80, v118
    v_mul_f32 v117, v81, v81
    v_fma_f32 v117, v117, s48, 1.0
    v_mul_f32 v117, v117, v81
    v_mul_f32 v117, s49, v117
    v_exp_f32 v118, -v117
    s_nop 0
    v_add_f32 v118, 1.0, v118
    v_rcp_f32 v118, v118
    s_nop 0
    v_mul_f32 v81, v81, v118
    v_cvt_pk_bf16_f32 v116, v82, v83
    v_lshlrev_b32 v82, 16, v116
    v_and_b32 v83, 0xffff0000, v116
    v_lshlrev_b32 v117, 16, v121
    v_and_b32 v118, 0xffff0000, v121
    v_add_f32 v82, v82, v117
    v_add_f32 v83, v83, v118
    v_cvt_pk_bf16_f32 v116, v82, v83
    v_lshlrev_b32 v82, 16, v116
    v_and_b32 v83, 0xffff0000, v116
    v_mul_f32 v117, v82, v82
    v_fma_f32 v117, v117, s48, 1.0
    v_mul_f32 v117, v117, v82
    v_mul_f32 v117, s49, v117
    v_exp_f32 v118, -v117
    s_nop 0
    v_add_f32 v118, 1.0, v118
    v_rcp_f32 v118, v118
    s_nop 0
    v_mul_f32 v82, v82, v118
    v_mul_f32 v117, v83, v83
    v_fma_f32 v117, v117, s48, 1.0
    v_mul_f32 v117, v117, v83
    v_mul_f32 v117, s49, v117
    v_exp_f32 v118, -v117
    s_nop 0
    v_add_f32 v118, 1.0, v118
    v_rcp_f32 v118, v118
    s_nop 0
    v_mul_f32 v83, v83, v118
    v_cvt_pk_bf16_f32 v116, v80, v81
    v_cvt_pk_bf16_f32 v117, v82, v83
    buffer_store_dwordx2 v[116:117], v112, s[36:39], s47 offen offset:0
    s_nop 1
    v_cvt_pk_bf16_f32 v116, v84, v85
    v_lshlrev_b32 v84, 16, v116
    v_and_b32 v85, 0xffff0000, v116
    v_lshlrev_b32 v117, 16, v122
    v_and_b32 v118, 0xffff0000, v122
    v_add_f32 v84, v84, v117
    v_add_f32 v85, v85, v118
    v_cvt_pk_bf16_f32 v116, v84, v85
    v_lshlrev_b32 v84, 16, v116
    v_and_b32 v85, 0xffff0000, v116
    v_mul_f32 v117, v84, v84
    v_fma_f32 v117, v117, s48, 1.0
    v_mul_f32 v117, v117, v84
    v_mul_f32 v117, s49, v117
    v_exp_f32 v118, -v117
    s_nop 0
    v_add_f32 v118, 1.0, v118
    v_rcp_f32 v118, v118
    s_nop 0
    v_mul_f32 v84, v84, v118
    v_mul_f32 v117, v85, v85
    v_fma_f32 v117, v117, s48, 1.0
    v_mul_f32 v117, v117, v85
    v_mul_f32 v117, s49, v117
    v_exp_f32 v118, -v117
    s_nop 0
    v_add_f32 v118, 1.0, v118
    v_rcp_f32 v118, v118
    s_nop 0
    v_mul_f32 v85, v85, v118
    v_cvt_pk_bf16_f32 v116, v86, v87
    v_lshlrev_b32 v86, 16, v116
    v_and_b32 v87, 0xffff0000, v116
    v_lshlrev_b32 v117, 16, v123
    v_and_b32 v118, 0xffff0000, v123
    v_add_f32 v86, v86, v117
    v_add_f32 v87, v87, v118
    v_cvt_pk_bf16_f32 v116, v86, v87
    v_lshlrev_b32 v86, 16, v116
    v_and_b32 v87, 0xffff0000, v116
    v_mul_f32 v117, v86, v86
    v_fma_f32 v117, v117, s48, 1.0
    v_mul_f32 v117, v117, v86
    v_mul_f32 v117, s49, v117
    v_exp_f32 v118, -v117
    s_nop 0
    v_add_f32 v118, 1.0, v118
    v_rcp_f32 v118, v118
    s_nop 0
    v_mul_f32 v86, v86, v118
    v_mul_f32 v117, v87, v87
    v_fma_f32 v117, v117, s48, 1.0
    v_mul_f32 v117, v117, v87
    v_mul_f32 v117, s49, v117
    v_exp_f32 v118, -v117
    s_nop 0
    v_add_f32 v118, 1.0, v118
    v_rcp_f32 v118, v118
    s_nop 0
    v_mul_f32 v87, v87, v118
    v_cvt_pk_bf16_f32 v116, v84, v85
    v_cvt_pk_bf16_f32 v117, v86, v87
    buffer_store_dwordx2 v[116:117], v112, s[36:39], s47 offen offset:16
    s_nop 1
    v_cvt_pk_bf16_f32 v116, v88, v89
    v_lshlrev_b32 v88, 16, v116
    v_and_b32 v89, 0xffff0000, v116
    v_lshlrev_b32 v117, 16, v124
    v_and_b32 v118, 0xffff0000, v124
    v_add_f32 v88, v88, v117
    v_add_f32 v89, v89, v118
    v_cvt_pk_bf16_f32 v116, v88, v89
    v_lshlrev_b32 v88, 16, v116
    v_and_b32 v89, 0xffff0000, v116
    v_mul_f32 v117, v88, v88
    v_fma_f32 v117, v117, s48, 1.0
    v_mul_f32 v117, v117, v88
    v_mul_f32 v117, s49, v117
    v_exp_f32 v118, -v117
    s_nop 0
    v_add_f32 v118, 1.0, v118
    v_rcp_f32 v118, v118
    s_nop 0
    v_mul_f32 v88, v88, v118
    v_mul_f32 v117, v89, v89
    v_fma_f32 v117, v117, s48, 1.0
    v_mul_f32 v117, v117, v89
    v_mul_f32 v117, s49, v117
    v_exp_f32 v118, -v117
    s_nop 0
    v_add_f32 v118, 1.0, v118
    v_rcp_f32 v118, v118
    s_nop 0
    v_mul_f32 v89, v89, v118
    v_cvt_pk_bf16_f32 v116, v90, v91
    v_lshlrev_b32 v90, 16, v116
    v_and_b32 v91, 0xffff0000, v116
    v_lshlrev_b32 v117, 16, v125
    v_and_b32 v118, 0xffff0000, v125
    v_add_f32 v90, v90, v117
    v_add_f32 v91, v91, v118
    v_cvt_pk_bf16_f32 v116, v90, v91
    v_lshlrev_b32 v90, 16, v116
    v_and_b32 v91, 0xffff0000, v116
    v_mul_f32 v117, v90, v90
    v_fma_f32 v117, v117, s48, 1.0
    v_mul_f32 v117, v117, v90
    v_mul_f32 v117, s49, v117
    v_exp_f32 v118, -v117
    s_nop 0
    v_add_f32 v118, 1.0, v118
    v_rcp_f32 v118, v118
    s_nop 0
    v_mul_f32 v90, v90, v118
    v_mul_f32 v117, v91, v91
    v_fma_f32 v117, v117, s48, 1.0
    v_mul_f32 v117, v117, v91
    v_mul_f32 v117, s49, v117
    v_exp_f32 v118, -v117
    s_nop 0
    v_add_f32 v118, 1.0, v118
    v_rcp_f32 v118, v118
    s_nop 0
    v_mul_f32 v91, v91, v118
    v_cvt_pk_bf16_f32 v116, v88, v89
    v_cvt_pk_bf16_f32 v117, v90, v91
    buffer_store_dwordx2 v[116:117], v112, s[36:39], s47 offen offset:32
    s_nop 1
    v_cvt_pk_bf16_f32 v116, v92, v93
    v_lshlrev_b32 v92, 16, v116
    v_and_b32 v93, 0xffff0000, v116
    v_lshlrev_b32 v117, 16, v126
    v_and_b32 v118, 0xffff0000, v126
    v_add_f32 v92, v92, v117
    v_add_f32 v93, v93, v118
    v_cvt_pk_bf16_f32 v116, v92, v93
    v_lshlrev_b32 v92, 16, v116
    v_and_b32 v93, 0xffff0000, v116
    v_mul_f32 v117, v92, v92
    v_fma_f32 v117, v117, s48, 1.0
    v_mul_f32 v117, v117, v92
    v_mul_f32 v117, s49, v117
    v_exp_f32 v118, -v117
    s_nop 0
    v_add_f32 v118, 1.0, v118
    v_rcp_f32 v118, v118
    s_nop 0
    v_mul_f32 v92, v92, v118
    v_mul_f32 v117, v93, v93
    v_fma_f32 v117, v117, s48, 1.0
    v_mul_f32 v117, v117, v93
    v_mul_f32 v117, s49, v117
    v_exp_f32 v118, -v117
    s_nop 0
    v_add_f32 v118, 1.0, v118
    v_rcp_f32 v118, v118
    s_nop 0
    v_mul_f32 v93, v93, v118
    v_cvt_pk_bf16_f32 v116, v94, v95
    v_lshlrev_b32 v94, 16, v116
    v_and_b32 v95, 0xffff0000, v116
    v_lshlrev_b32 v117, 16, v127
    v_and_b32 v118, 0xffff0000, v127
    v_add_f32 v94, v94, v117
    v_add_f32 v95, v95, v118
    v_cvt_pk_bf16_f32 v116, v94, v95
    v_lshlrev_b32 v94, 16, v116
    v_and_b32 v95, 0xffff0000, v116
    v_mul_f32 v117, v94, v94
    v_fma_f32 v117, v117, s48, 1.0
    v_mul_f32 v117, v117, v94
    v_mul_f32 v117, s49, v117
    v_exp_f32 v118, -v117
    s_nop 0
    v_add_f32 v118, 1.0, v118
    v_rcp_f32 v118, v118
    s_nop 0
    v_mul_f32 v94, v94, v118
    v_mul_f32 v117, v95, v95
    v_fma_f32 v117, v117, s48, 1.0
    v_mul_f32 v117, v117, v95
    v_mul_f32 v117, s49, v117
    v_exp_f32 v118, -v117
    s_nop 0
    v_add_f32 v118, 1.0, v118
    v_rcp_f32 v118, v118
    s_nop 0
    v_mul_f32 v95, v95, v118
    v_cvt_pk_bf16_f32 v116, v92, v93
    v_cvt_pk_bf16_f32 v117, v94, v95
    buffer_store_dwordx2 v[116:117], v112, s[36:39], s47 offen offset:48
    s_nop 1
    v_cvt_pk_bf16_f32 v116, v96, v97
    v_lshlrev_b32 v96, 16, v116
    v_and_b32 v97, 0xffff0000, v116
    v_lshlrev_b32 v117, 16, v128
    v_and_b32 v118, 0xffff0000, v128
    v_add_f32 v96, v96, v117
    v_add_f32 v97, v97, v118
    v_cvt_pk_bf16_f32 v116, v96, v97
    v_lshlrev_b32 v96, 16, v116
    v_and_b32 v97, 0xffff0000, v116
    v_mul_f32 v117, v96, v96
    v_fma_f32 v117, v117, s48, 1.0
    v_mul_f32 v117, v117, v96
    v_mul_f32 v117, s49, v117
    v_exp_f32 v118, -v117
    s_nop 0
    v_add_f32 v118, 1.0, v118
    v_rcp_f32 v118, v118
    s_nop 0
    v_mul_f32 v96, v96, v118
    v_mul_f32 v117, v97, v97
    v_fma_f32 v117, v117, s48, 1.0
    v_mul_f32 v117, v117, v97
    v_mul_f32 v117, s49, v117
    v_exp_f32 v118, -v117
    s_nop 0
    v_add_f32 v118, 1.0, v118
    v_rcp_f32 v118, v118
    s_nop 0
    v_mul_f32 v97, v97, v118
    v_cvt_pk_bf16_f32 v116, v98, v99
    v_lshlrev_b32 v98, 16, v116
    v_and_b32 v99, 0xffff0000, v116
    v_lshlrev_b32 v117, 16, v129
    v_and_b32 v118, 0xffff0000, v129
    v_add_f32 v98, v98, v117
    v_add_f32 v99, v99, v118
    v_cvt_pk_bf16_f32 v116, v98, v99
    v_lshlrev_b32 v98, 16, v116
    v_and_b32 v99, 0xffff0000, v116
    v_mul_f32 v117, v98, v98
    v_fma_f32 v117, v117, s48, 1.0
    v_mul_f32 v117, v117, v98
    v_mul_f32 v117, s49, v117
    v_exp_f32 v118, -v117
    s_nop 0
    v_add_f32 v118, 1.0, v118
    v_rcp_f32 v118, v118
    s_nop 0
    v_mul_f32 v98, v98, v118
    v_mul_f32 v117, v99, v99
    v_fma_f32 v117, v117, s48, 1.0
    v_mul_f32 v117, v117, v99
    v_mul_f32 v117, s49, v117
    v_exp_f32 v118, -v117
    s_nop 0
    v_add_f32 v118, 1.0, v118
    v_rcp_f32 v118, v118
    s_nop 0
    v_mul_f32 v99, v99, v118
    v_cvt_pk_bf16_f32 v116, v96, v97
    v_cvt_pk_bf16_f32 v117, v98, v99
    buffer_store_dwordx2 v[116:117], v112, s[36:39], s47 offen offset:64
    s_nop 1
    v_cvt_pk_bf16_f32 v116, v100, v101
    v_lshlrev_b32 v100, 16, v116
    v_and_b32 v101, 0xffff0000, v116
    v_lshlrev_b32 v117, 16, v130
    v_and_b32 v118, 0xffff0000, v130
    v_add_f32 v100, v100, v117
    v_add_f32 v101, v101, v118
    v_cvt_pk_bf16_f32 v116, v100, v101
    v_lshlrev_b32 v100, 16, v116
    v_and_b32 v101, 0xffff0000, v116
    v_mul_f32 v117, v100, v100
    v_fma_f32 v117, v117, s48, 1.0
    v_mul_f32 v117, v117, v100
    v_mul_f32 v117, s49, v117
    v_exp_f32 v118, -v117
    s_nop 0
    v_add_f32 v118, 1.0, v118
    v_rcp_f32 v118, v118
    s_nop 0
    v_mul_f32 v100, v100, v118
    v_mul_f32 v117, v101, v101
    v_fma_f32 v117, v117, s48, 1.0
    v_mul_f32 v117, v117, v101
    v_mul_f32 v117, s49, v117
    v_exp_f32 v118, -v117
    s_nop 0
    v_add_f32 v118, 1.0, v118
    v_rcp_f32 v118, v118
    s_nop 0
    v_mul_f32 v101, v101, v118
    v_cvt_pk_bf16_f32 v116, v102, v103
    v_lshlrev_b32 v102, 16, v116
    v_and_b32 v103, 0xffff0000, v116
    v_lshlrev_b32 v117, 16, v131
    v_and_b32 v118, 0xffff0000, v131
    v_add_f32 v102, v102, v117
    v_add_f32 v103, v103, v118
    v_cvt_pk_bf16_f32 v116, v102, v103
    v_lshlrev_b32 v102, 16, v116
    v_and_b32 v103, 0xffff0000, v116
    v_mul_f32 v117, v102, v102
    v_fma_f32 v117, v117, s48, 1.0
    v_mul_f32 v117, v117, v102
    v_mul_f32 v117, s49, v117
    v_exp_f32 v118, -v117
    s_nop 0
    v_add_f32 v118, 1.0, v118
    v_rcp_f32 v118, v118
    s_nop 0
    v_mul_f32 v102, v102, v118
    v_mul_f32 v117, v103, v103
    v_fma_f32 v117, v117, s48, 1.0
    v_mul_f32 v117, v117, v103
    v_mul_f32 v117, s49, v117
    v_exp_f32 v118, -v117
    s_nop 0
    v_add_f32 v118, 1.0, v118
    v_rcp_f32 v118, v118
    s_nop 0
    v_mul_f32 v103, v103, v118
    v_cvt_pk_bf16_f32 v116, v100, v101
    v_cvt_pk_bf16_f32 v117, v102, v103
    buffer_store_dwordx2 v[116:117], v112, s[36:39], s47 offen offset:80
    s_nop 1
    v_cvt_pk_bf16_f32 v116, v104, v105
    v_lshlrev_b32 v104, 16, v116
    v_and_b32 v105, 0xffff0000, v116
    v_lshlrev_b32 v117, 16, v132
    v_and_b32 v118, 0xffff0000, v132
    v_add_f32 v104, v104, v117
    v_add_f32 v105, v105, v118
    v_cvt_pk_bf16_f32 v116, v104, v105
    v_lshlrev_b32 v104, 16, v116
    v_and_b32 v105, 0xffff0000, v116
    v_mul_f32 v117, v104, v104
    v_fma_f32 v117, v117, s48, 1.0
    v_mul_f32 v117, v117, v104
    v_mul_f32 v117, s49, v117
    v_exp_f32 v118, -v117
    s_nop 0
    v_add_f32 v118, 1.0, v118
    v_rcp_f32 v118, v118
    s_nop 0
    v_mul_f32 v104, v104, v118
    v_mul_f32 v117, v105, v105
    v_fma_f32 v117, v117, s48, 1.0
    v_mul_f32 v117, v117, v105
    v_mul_f32 v117, s49, v117
    v_exp_f32 v118, -v117
    s_nop 0
    v_add_f32 v118, 1.0, v118
    v_rcp_f32 v118, v118
    s_nop 0
    v_mul_f32 v105, v105, v118
    v_cvt_pk_bf16_f32 v116, v106, v107
    v_lshlrev_b32 v106, 16, v116
    v_and_b32 v107, 0xffff0000, v116
    v_lshlrev_b32 v117, 16, v133
    v_and_b32 v118, 0xffff0000, v133
    v_add_f32 v106, v106, v117
    v_add_f32 v107, v107, v118
    v_cvt_pk_bf16_f32 v116, v106, v107
    v_lshlrev_b32 v106, 16, v116
    v_and_b32 v107, 0xffff0000, v116
    v_mul_f32 v117, v106, v106
    v_fma_f32 v117, v117, s48, 1.0
    v_mul_f32 v117, v117, v106
    v_mul_f32 v117, s49, v117
    v_exp_f32 v118, -v117
    s_nop 0
    v_add_f32 v118, 1.0, v118
    v_rcp_f32 v118, v118
    s_nop 0
    v_mul_f32 v106, v106, v118
    v_mul_f32 v117, v107, v107
    v_fma_f32 v117, v117, s48, 1.0
    v_mul_f32 v117, v117, v107
    v_mul_f32 v117, s49, v117
    v_exp_f32 v118, -v117
    s_nop 0
    v_add_f32 v118, 1.0, v118
    v_rcp_f32 v118, v118
    s_nop 0
    v_mul_f32 v107, v107, v118
    v_cvt_pk_bf16_f32 v116, v104, v105
    v_cvt_pk_bf16_f32 v117, v106, v107
    buffer_store_dwordx2 v[116:117], v112, s[36:39], s47 offen offset:96
    s_nop 1
    v_cvt_pk_bf16_f32 v116, v108, v109
    v_lshlrev_b32 v108, 16, v116
    v_and_b32 v109, 0xffff0000, v116
    v_lshlrev_b32 v117, 16, v134
    v_and_b32 v118, 0xffff0000, v134
    v_add_f32 v108, v108, v117
    v_add_f32 v109, v109, v118
    v_cvt_pk_bf16_f32 v116, v108, v109
    v_lshlrev_b32 v108, 16, v116
    v_and_b32 v109, 0xffff0000, v116
    v_mul_f32 v117, v108, v108
    v_fma_f32 v117, v117, s48, 1.0
    v_mul_f32 v117, v117, v108
    v_mul_f32 v117, s49, v117
    v_exp_f32 v118, -v117
    s_nop 0
    v_add_f32 v118, 1.0, v118
    v_rcp_f32 v118, v118
    s_nop 0
    v_mul_f32 v108, v108, v118
    v_mul_f32 v117, v109, v109
    v_fma_f32 v117, v117, s48, 1.0
    v_mul_f32 v117, v117, v109
    v_mul_f32 v117, s49, v117
    v_exp_f32 v118, -v117
    s_nop 0
    v_add_f32 v118, 1.0, v118
    v_rcp_f32 v118, v118
    s_nop 0
    v_mul_f32 v109, v109, v118
    v_cvt_pk_bf16_f32 v116, v110, v111
    v_lshlrev_b32 v110, 16, v116
    v_and_b32 v111, 0xffff0000, v116
    v_lshlrev_b32 v117, 16, v135
    v_and_b32 v118, 0xffff0000, v135
    v_add_f32 v110, v110, v117
    v_add_f32 v111, v111, v118
    v_cvt_pk_bf16_f32 v116, v110, v111
    v_lshlrev_b32 v110, 16, v116
    v_and_b32 v111, 0xffff0000, v116
    v_mul_f32 v117, v110, v110
    v_fma_f32 v117, v117, s48, 1.0
    v_mul_f32 v117, v117, v110
    v_mul_f32 v117, s49, v117
    v_exp_f32 v118, -v117
    s_nop 0
    v_add_f32 v118, 1.0, v118
    v_rcp_f32 v118, v118
    s_nop 0
    v_mul_f32 v110, v110, v118
    v_mul_f32 v117, v111, v111
    v_fma_f32 v117, v117, s48, 1.0
    v_mul_f32 v117, v117, v111
    v_mul_f32 v117, s49, v117
    v_exp_f32 v118, -v117
    s_nop 0
    v_add_f32 v118, 1.0, v118
    v_rcp_f32 v118, v118
    s_nop 0
    v_mul_f32 v111, v111, v118
    v_cvt_pk_bf16_f32 v116, v108, v109
    v_cvt_pk_bf16_f32 v117, v110, v111
    buffer_store_dwordx2 v[116:117], v112, s[36:39], s47 offen offset:112
    s_nop 1
L_proj_done:
    s_endpgm
.globl attn_kernel
.p2align 8
.type attn_kernel,@function
attn_kernel:
    s_cmp_ge_u32 s2, 256
    s_cbranch_scc1 L_attn_done
    s_load_dwordx2 s[4:5], s[0:1], 96
    s_load_dwordx2 s[6:7], s[0:1], 8
    s_load_dwordx2 s[8:9], s[0:1], 16
    v_lshrrev_b32 v1, 6, v0
    s_nop 0
    v_readfirstlane_b32 s3, v1
    s_and_b32 s24, s2, 7
    s_lshl_b32 s24, s24, 2
    s_bfe_u32 s25, s2, 0x20003
    s_add_u32 s24, s24, s25
    s_lshr_b32 s25, s2, 5
    s_waitcnt lgkmcnt(0)
    s_add_u32 s12, s4, 5242880
    s_addc_u32 s13, s5, 0
    s_mov_b32 s28, s12
    s_and_b32 s29, s13, 0xffff
    s_mov_b32 s30, 25165824
    s_mov_b32 s31, 0x00020000
    s_mul_i32 s14, s24, 786432
    s_add_u32 s12, s6, s14
    s_addc_u32 s13, s7, 0
    s_mov_b32 s32, s12
    s_and_b32 s33, s13, 0xffff
    s_mov_b32 s34, 786432
    s_mov_b32 s35, 0x00020000
    s_add_u32 s12, s8, s14
    s_addc_u32 s13, s9, 0
    s_mov_b32 s36, s12
    s_and_b32 s37, s13, 0xffff
    s_mov_b32 s38, 786432
    s_mov_b32 s39, 0x00020000
    v_and_b32 v246, 31, v0
    v_bfe_u32 v247, v0, 5, 1
    s_lshl_b32 s14, s25, 8
    s_lshl_b32 s15, s3, 5
    s_add_u32 s14, s14, s15
    v_add_u32 v2, s14, v246
    v_mul_u32_u24 v2, 12288, v2
    s_mul_i32 s14, s24, 384
    v_add_u32 v2, s14, v2
    v_lshl_add_u32 v3, v247, 4, v2
    buffer_load_dwordx4 v[8:11], v3, s[28:31], 0 offen offset:0
    buffer_load_dwordx4 v[12:15], v3, s[28:31], 0 offen offset:32
    buffer_load_dwordx4 v[16:19], v3, s[28:31], 0 offen offset:64
    buffer_load_dwordx4 v[20:23], v3, s[28:31], 0 offen offset:96
    buffer_load_dwordx4 v[24:27], v3, s[28:31], 0 offen offset:128
    buffer_load_dwordx4 v[28:31], v3, s[28:31], 0 offen offset:160
    buffer_load_dwordx4 v[32:35], v3, s[28:31], 0 offen offset:192
    buffer_load_dwordx4 v[36:39], v3, s[28:31], 0 offen offset:224
    buffer_load_dwordx4 v[40:43], v3, s[28:31], 0 offen offset:256
    buffer_load_dwordx4 v[44:47], v3, s[28:31], 0 offen offset:288
    buffer_load_dwordx4 v[48:51], v3, s[28:31], 0 offen offset:320
    buffer_load_dwordx4 v[52:55], v3, s[28:31], 0 offen offset:352
    v_mul_u32_u24 v248, 384, v246
    v_bfe_u32 v249, v0, 1, 3
    v_add_u32 v250, 0, v247
    v_xor_b32 v250, v250, v249
    v_lshl_add_u32 v232, v250, 4, v248
    v_add_u32 v250, 2, v247
    v_xor_b32 v250, v250, v249
    v_lshl_add_u32 v233, v250, 4, v248
    v_add_u32 v250, 4, v247
    v_xor_b32 v250, v250, v249
    v_lshl_add_u32 v234, v250, 4, v248
    v_add_u32 v250, 6, v247
    v_xor_b32 v250, v250, v249
    v_lshl_add_u32 v235, v250, 4, v248
    v_bfe_u32 v248, v0, 2, 2
    v_lshl_add_u32 v249, v247, 2, v248
    v_mul_u32_u24 v249, 384, v249
    v_bfe_u32 v250, v0, 4, 1
    v_lshl_add_u32 v249, v250, 5, v249
    v_and_b32 v250, 3, v0
    v_lshl_add_u32 v249, v250, 3, v249
    v_add_u32 v249, 49152, v249
    v_bfe_u32 v250, v0, 3, 1
    v_lshlrev_b32 v250, 6, v250
    v_add_u32 v236, v249, v250
    v_sub_u32 v237, v249, v250
    v_and_b32 v246, 63, v0
    s_mov_b32 s15, 2731
    s_mul_i32 s14, s3, 192
    s_add_u32 s14, s14, 0
    v_add_u32 v247, s14, v246
    v_mul_lo_u32 v248, v247, s15
    v_lshrrev_b32 v248, 16, v248
    v_mul_u32_u24 v249, 24, v248
    v_sub_u32 v249, v247, v249
    v_mul_u32_u24 v251, 384, v248
    v_bfe_u32 v250, v248, 1, 3
    v_xor_b32 v250, v249, v250
    v_lshl_add_u32 v238, v250, 4, v251
    v_bfe_u32 v250, v248, 1, 1
    v_lshlrev_b32 v250, 2, v250
    v_xor_b32 v250, v249, v250
    v_lshl_add_u32 v241, v250, 4, v251
    s_mul_i32 s14, s3, 192
    s_add_u32 s14, s14, 64
    v_add_u32 v247, s14, v246
    v_mul_lo_u32 v248, v247, s15
    v_lshrrev_b32 v248, 16, v248
    v_mul_u32_u24 v249, 24, v248
    v_sub_u32 v249, v247, v249
    v_mul_u32_u24 v251, 384, v248
    v_bfe_u32 v250, v248, 1, 3
    v_xor_b32 v250, v249, v250
    v_lshl_add_u32 v239, v250, 4, v251
    v_bfe_u32 v250, v248, 1, 1
    v_lshlrev_b32 v250, 2, v250
    v_xor_b32 v250, v249, v250
    v_lshl_add_u32 v242, v250, 4, v251
    s_mul_i32 s14, s3, 192
    s_add_u32 s14, s14, 128
    v_add_u32 v247, s14, v246
    v_mul_lo_u32 v248, v247, s15
    v_lshrrev_b32 v248, 16, v248
    v_mul_u32_u24 v249, 24, v248
    v_sub_u32 v249, v247, v249
    v_mul_u32_u24 v251, 384, v248
    v_bfe_u32 v250, v248, 1, 3
    v_xor_b32 v250, v249, v250
    v_lshl_add_u32 v240, v250, 4, v251
    v_bfe_u32 v250, v248, 1, 1
    v_lshlrev_b32 v250, 2, v250
    v_xor_b32 v250, v249, v250
    v_lshl_add_u32 v243, v250, 4, v251
    v_mov_b32 v56, 0
    v_mov_b32 v57, 0
    v_mov_b32 v58, 0
    v_mov_b32 v59, 0
    v_mov_b32 v60, 0
    v_mov_b32 v61, 0
    v_mov_b32 v62, 0
    v_mov_b32 v63, 0
    v_mov_b32 v64, 0
    v_mov_b32 v65, 0
    v_mov_b32 v66, 0
    v_mov_b32 v67, 0
    v_mov_b32 v68, 0
    v_mov_b32 v69, 0
    v_mov_b32 v70, 0
    v_mov_b32 v71, 0
    v_mov_b32 v72, 0
    v_mov_b32 v73, 0
    v_mov_b32 v74, 0
    v_mov_b32 v75, 0
    v_mov_b32 v76, 0
    v_mov_b32 v77, 0
    v_mov_b32 v78, 0
    v_mov_b32 v79, 0
    v_mov_b32 v80, 0
    v_mov_b32 v81, 0
    v_mov_b32 v82, 0
    v_mov_b32 v83, 0
    v_mov_b32 v84, 0
    v_mov_b32 v85, 0
    v_mov_b32 v86, 0
    v_mov_b32 v87, 0
    v_mov_b32 v88, 0
    v_mov_b32 v89, 0
    v_mov_b32 v90, 0
    v_mov_b32 v91, 0
    v_mov_b32 v92, 0
    v_mov_b32 v93, 0
    v_mov_b32 v94, 0
    v_mov_b32 v95, 0
    v_mov_b32 v96, 0
    v_mov_b32 v97, 0
    v_mov_b32 v98, 0
    v_mov_b32 v99, 0
    v_mov_b32 v100, 0
    v_mov_b32 v101, 0
    v_mov_b32 v102, 0
    v_mov_b32 v103, 0
    v_mov_b32 v104, 0
    v_mov_b32 v105, 0
    v_mov_b32 v106, 0
    v_mov_b32 v107, 0
    v_mov_b32 v108, 0
    v_mov_b32 v109, 0
    v_mov_b32 v110, 0
    v_mov_b32 v111, 0
    v_mov_b32 v112, 0
    v_mov_b32 v113, 0
    v_mov_b32 v114, 0
    v_mov_b32 v115, 0
    v_mov_b32 v116, 0
    v_mov_b32 v117, 0
    v_mov_b32 v118, 0
    v_mov_b32 v119, 0
    v_mov_b32 v120, 0
    v_mov_b32 v121, 0
    v_mov_b32 v122, 0
    v_mov_b32 v123, 0
    v_mov_b32 v124, 0
    v_mov_b32 v125, 0
    v_mov_b32 v126, 0
    v_mov_b32 v127, 0
    v_mov_b32 v128, 0
    v_mov_b32 v129, 0
    v_mov_b32 v130, 0
    v_mov_b32 v131, 0
    v_mov_b32 v132, 0
    v_mov_b32 v133, 0
    v_mov_b32 v134, 0
    v_mov_b32 v135, 0
    v_mov_b32 v136, 0
    v_mov_b32 v137, 0
    v_mov_b32 v138, 0
    v_mov_b32 v139, 0
    v_mov_b32 v140, 0
    v_mov_b32 v141, 0
    v_mov_b32 v142, 0
    v_mov_b32 v143, 0
    v_mov_b32 v144, 0
    v_mov_b32 v145, 0
    v_mov_b32 v146, 0
    v_mov_b32 v147, 0
    v_mov_b32 v148, 0
    v_mov_b32 v149, 0
    v_mov_b32 v150, 0
    v_mov_b32 v151, 0
    v_mov_b32 v244, 0xff800000
    v_mov_b32 v245, 0
    s_mov_b32 s40, 0x3dd53b95
    s_mov_b32 s44, 0x4299ac27
    s_mul_i32 s41, s3, 3072
    s_mov_b32 s42, 0
    s_add_u32 s14, s41, 0
    s_mov_b32 m0, s14
    s_add_u32 s14, s41, 49152
    buffer_load_dwordx4 v238, s[32:35], s42 offen lds
    s_mov_b32 m0, s14
    s_nop 0
    buffer_load_dwordx4 v241, s[36:39], s42 offen lds
    s_add_u32 s14, s41, 1024
    s_mov_b32 m0, s14
    s_add_u32 s14, s41, 50176
    buffer_load_dwordx4 v239, s[32:35], s42 offen lds
    s_mov_b32 m0, s14
    s_nop 0
    buffer_load_dwordx4 v242, s[36:39], s42 offen lds
    s_add_u32 s14, s41, 2048
    s_mov_b32 m0, s14
    s_add_u32 s14, s41, 51200
    buffer_load_dwordx4 v240, s[32:35], s42 offen lds
    s_mov_b32 m0, s14
    s_nop 0
    buffer_load_dwordx4 v243, s[36:39], s42 offen lds
    s_mov_b32 s43, 0
L_attn_loop:
    s_waitcnt vmcnt(0)
    s_barrier
    s_add_u32 s42, s42, 24576
    s_add_u32 s14, s41, 24576
    s_mov_b32 m0, s14
    s_add_u32 s14, s41, 73728
    buffer_load_dwordx4 v238, s[32:35], s42 offen lds
    s_mov_b32 m0, s14
    s_nop 0
    buffer_load_dwordx4 v241, s[36:39], s42 offen lds
    s_add_u32 s14, s41, 25600
    s_mov_b32 m0, s14
    s_add_u32 s14, s41, 74752
    buffer_load_dwordx4 v239, s[32:35], s42 offen lds
    s_mov_b32 m0, s14
    s_nop 0
    buffer_load_dwordx4 v242, s[36:39], s42 offen lds
    s_add_u32 s14, s41, 26624
    s_mov_b32 m0, s14
    s_add_u32 s14, s41, 75776
    buffer_load_dwordx4 v240, s[32:35], s42 offen lds
    s_mov_b32 m0, s14
    s_nop 0
    buffer_load_dwordx4 v243, s[36:39], s42 offen lds
    ds_read_b128 v[200:203], v232 offset:0
    ds_read_b128 v[204:207], v233 offset:0
    ds_read_b128 v[208:211], v234 offset:0
    ds_read_b128 v[212:215], v235 offset:0
    s_waitcnt lgkmcnt(3)
    v_mfma_f32_32x32x16_bf16 v[152:167], v[200:203], v[8:11], 0
    ds_read_b128 v[200:203], v232 offset:128
    s_waitcnt lgkmcnt(3)
    v_mfma_f32_32x32x16_bf16 v[152:167], v[204:207], v[12:15], v[152:167]
    ds_read_b128 v[204:207], v233 offset:128
    s_waitcnt lgkmcnt(3)
    v_mfma_f32_32x32x16_bf16 v[152:167], v[208:211], v[16:19], v[152:167]
    ds_read_b128 v[208:211], v234 offset:128
    s_waitcnt lgkmcnt(3)
    v_mfma_f32_32x32x16_bf16 v[152:167], v[212:215], v[20:23], v[152:167]
    ds_read_b128 v[212:215], v235 offset:128
    s_waitcnt lgkmcnt(3)
    v_mfma_f32_32x32x16_bf16 v[152:167], v[200:203], v[24:27], v[152:167]
    ds_read_b128 v[200:203], v232 offset:256
    s_waitcnt lgkmcnt(3)
    v_mfma_f32_32x32x16_bf16 v[152:167], v[204:207], v[28:31], v[152:167]
    ds_read_b128 v[204:207], v233 offset:256
    s_waitcnt lgkmcnt(3)
    v_mfma_f32_32x32x16_bf16 v[152:167], v[208:211], v[32:35], v[152:167]
    ds_read_b128 v[208:211], v234 offset:256
    s_waitcnt lgkmcnt(3)
    v_mfma_f32_32x32x16_bf16 v[152:167], v[212:215], v[36:39], v[152:167]
    ds_read_b128 v[212:215], v235 offset:256
    s_waitcnt lgkmcnt(3)
    v_mfma_f32_32x32x16_bf16 v[152:167], v[200:203], v[40:43], v[152:167]
    s_waitcnt lgkmcnt(2)
    v_mfma_f32_32x32x16_bf16 v[152:167], v[204:207], v[44:47], v[152:167]
    s_waitcnt lgkmcnt(1)
    v_mfma_f32_32x32x16_bf16 v[152:167], v[208:211], v[48:51], v[152:167]
    s_waitcnt lgkmcnt(0)
    v_mfma_f32_32x32x16_bf16 v[152:167], v[212:215], v[52:55], v[152:167]
    s_nop 7
    s_nop 7
    v_max3_f32 v246, v152, v153, v154
    v_max3_f32 v246, v246, v155, v156
    v_max3_f32 v246, v246, v157, v158
    v_max3_f32 v246, v246, v159, v160
    v_max3_f32 v246, v246, v161, v162
    v_max3_f32 v246, v246, v163, v164
    v_max3_f32 v246, v246, v165, v166
    v_max_f32 v246, v246, v167
    v_mov_b32 v247, v246
    v_mov_b32 v248, v246
    s_nop 1
    v_permlane32_swap_b32 v247, v248
    s_nop 1
    v_max3_f32 v246, v247, v248, v244
    v_add_f32 v249, s44, v244
    v_cmp_gt_f32 vcc, v246, v249
    s_nop 4
    s_cbranch_vccz L_attn_skip00
    v_sub_f32 v247, v244, v246
    v_mul_f32 v247, s40, v247
    v_exp_f32 v247, v247
    v_mov_b32 v244, v246
    v_mul_f32 v245, v245, v247
    v_mul_f32 v56, v56, v247
    v_mul_f32 v57, v57, v247
    v_mul_f32 v58, v58, v247
    v_mul_f32 v59, v59, v247
    v_mul_f32 v60, v60, v247
    v_mul_f32 v61, v61, v247
    v_mul_f32 v62, v62, v247
    v_mul_f32 v63, v63, v247
    v_mul_f32 v64, v64, v247
    v_mul_f32 v65, v65, v247
    v_mul_f32 v66, v66, v247
    v_mul_f32 v67, v67, v247
    v_mul_f32 v68, v68, v247
    v_mul_f32 v69, v69, v247
    v_mul_f32 v70, v70, v247
    v_mul_f32 v71, v71, v247
    v_mul_f32 v72, v72, v247
    v_mul_f32 v73, v73, v247
    v_mul_f32 v74, v74, v247
    v_mul_f32 v75, v75, v247
    v_mul_f32 v76, v76, v247
    v_mul_f32 v77, v77, v247
    v_mul_f32 v78, v78, v247
    v_mul_f32 v79, v79, v247
    v_mul_f32 v80, v80, v247
    v_mul_f32 v81, v81, v247
    v_mul_f32 v82, v82, v247
    v_mul_f32 v83, v83, v247
    v_mul_f32 v84, v84, v247
    v_mul_f32 v85, v85, v247
    v_mul_f32 v86, v86, v247
    v_mul_f32 v87, v87, v247
    v_mul_f32 v88, v88, v247
    v_mul_f32 v89, v89, v247
    v_mul_f32 v90, v90, v247
    v_mul_f32 v91, v91, v247
    v_mul_f32 v92, v92, v247
    v_mul_f32 v93, v93, v247
    v_mul_f32 v94, v94, v247
    v_mul_f32 v95, v95, v247
    v_mul_f32 v96, v96, v247
    v_mul_f32 v97, v97, v247
    v_mul_f32 v98, v98, v247
    v_mul_f32 v99, v99, v247
    v_mul_f32 v100, v100, v247
    v_mul_f32 v101, v101, v247
    v_mul_f32 v102, v102, v247
    v_mul_f32 v103, v103, v247
    v_mul_f32 v104, v104, v247
    v_mul_f32 v105, v105, v247
    v_mul_f32 v106, v106, v247
    v_mul_f32 v107, v107, v247
    v_mul_f32 v108, v108, v247
    v_mul_f32 v109, v109, v247
    v_mul_f32 v110, v110, v247
    v_mul_f32 v111, v111, v247
    v_mul_f32 v112, v112, v247
    v_mul_f32 v113, v113, v247
    v_mul_f32 v114, v114, v247
    v_mul_f32 v115, v115, v247
    v_mul_f32 v116, v116, v247
    v_mul_f32 v117, v117, v247
    v_mul_f32 v118, v118, v247
    v_mul_f32 v119, v119, v247
    v_mul_f32 v120, v120, v247
    v_mul_f32 v121, v121, v247
    v_mul_f32 v122, v122, v247
    v_mul_f32 v123, v123, v247
    v_mul_f32 v124, v124, v247
    v_mul_f32 v125, v125, v247
    v_mul_f32 v126, v126, v247
    v_mul_f32 v127, v127, v247
    v_mul_f32 v128, v128, v247
    v_mul_f32 v129, v129, v247
    v_mul_f32 v130, v130, v247
    v_mul_f32 v131, v131, v247
    v_mul_f32 v132, v132, v247
    v_mul_f32 v133, v133, v247
    v_mul_f32 v134, v134, v247
    v_mul_f32 v135, v135, v247
    v_mul_f32 v136, v136, v247
    v_mul_f32 v137, v137, v247
    v_mul_f32 v138, v138, v247
    v_mul_f32 v139, v139, v247
    v_mul_f32 v140, v140, v247
    v_mul_f32 v141, v141, v247
    v_mul_f32 v142, v142, v247
    v_mul_f32 v143, v143, v247
    v_mul_f32 v144, v144, v247
    v_mul_f32 v145, v145, v247
    v_mul_f32 v146, v146, v247
    v_mul_f32 v147, v147, v247
    v_mul_f32 v148, v148, v247
    v_mul_f32 v149, v149, v247
    v_mul_f32 v150, v150, v247
    v_mul_f32 v151, v151, v247
L_attn_skip00:
    v_mul_f32 v248, s40, v244
    v_fma_f32 v152, v152, s40, -v248
    v_exp_f32 v152, v152
    v_fma_f32 v153, v153, s40, -v248
    v_exp_f32 v153, v153
    v_fma_f32 v154, v154, s40, -v248
    v_exp_f32 v154, v154
    v_fma_f32 v155, v155, s40, -v248
    v_exp_f32 v155, v155
    v_fma_f32 v156, v156, s40, -v248
    v_exp_f32 v156, v156
    v_fma_f32 v157, v157, s40, -v248
    v_exp_f32 v157, v157
    v_fma_f32 v158, v158, s40, -v248
    v_exp_f32 v158, v158
    v_fma_f32 v159, v159, s40, -v248
    v_exp_f32 v159, v159
    v_fma_f32 v160, v160, s40, -v248
    v_exp_f32 v160, v160
    v_fma_f32 v161, v161, s40, -v248
    v_exp_f32 v161, v161
    v_fma_f32 v162, v162, s40, -v248
    v_exp_f32 v162, v162
    v_fma_f32 v163, v163, s40, -v248
    v_exp_f32 v163, v163
    v_fma_f32 v164, v164, s40, -v248
    v_exp_f32 v164, v164
    v_fma_f32 v165, v165, s40, -v248
    v_exp_f32 v165, v165
    v_fma_f32 v166, v166, s40, -v248
    v_exp_f32 v166, v166
    v_fma_f32 v167, v167, s40, -v248
    v_exp_f32 v167, v167
    v_add_f32 v245, v245, v152
    v_add_f32 v245, v245, v153
    v_add_f32 v245, v245, v154
    v_add_f32 v245, v245, v155
    v_add_f32 v245, v245, v156
    v_add_f32 v245, v245, v157
    v_add_f32 v245, v245, v158
    v_add_f32 v245, v245, v159
    v_add_f32 v245, v245, v160
    v_add_f32 v245, v245, v161
    v_add_f32 v245, v245, v162
    v_add_f32 v245, v245, v163
    v_add_f32 v245, v245, v164
    v_add_f32 v245, v245, v165
    v_add_f32 v245, v245, v166
    v_add_f32 v245, v245, v167
    v_cvt_pk_bf16_f32 v184, v152, v153
    v_cvt_pk_bf16_f32 v185, v154, v155
    v_cvt_pk_bf16_f32 v186, v156, v157
    v_cvt_pk_bf16_f32 v187, v158, v159
    v_cvt_pk_bf16_f32 v188, v160, v161
    v_cvt_pk_bf16_f32 v189, v162, v163
    v_cvt_pk_bf16_f32 v190, v164, v165
    v_cvt_pk_bf16_f32 v191, v166, v167
    s_nop 1
    ds_read_b64_tr_b16 v[216:217], v236 offset:0
    ds_read_b64_tr_b16 v[218:219], v236 offset:3072
    ds_read_b64_tr_b16 v[220:221], v237 offset:64
    ds_read_b64_tr_b16 v[222:223], v237 offset:3136
    ds_read_b64_tr_b16 v[224:225], v236 offset:128
    ds_read_b64_tr_b16 v[226:227], v236 offset:3200
    ds_read_b64_tr_b16 v[228:229], v237 offset:192
    ds_read_b64_tr_b16 v[230:231], v237 offset:3264
    s_waitcnt lgkmcnt(6)
    v_mfma_f32_32x32x16_bf16 v[56:71], v[216:219], v[184:187], v[56:71]
    ds_read_b64_tr_b16 v[216:217], v236 offset:256
    ds_read_b64_tr_b16 v[218:219], v236 offset:3328
    s_waitcnt lgkmcnt(6)
    v_mfma_f32_32x32x16_bf16 v[72:87], v[220:223], v[184:187], v[72:87]
    ds_read_b64_tr_b16 v[220:221], v237 offset:320
    ds_read_b64_tr_b16 v[222:223], v237 offset:3392
    s_waitcnt lgkmcnt(6)
    v_mfma_f32_32x32x16_bf16 v[88:103], v[224:227], v[184:187], v[88:103]
    ds_read_b64_tr_b16 v[224:225], v236 offset:6144
    ds_read_b64_tr_b16 v[226:227], v236 offset:9216
    s_waitcnt lgkmcnt(6)
    v_mfma_f32_32x32x16_bf16 v[104:119], v[228:231], v[184:187], v[104:119]
    ds_read_b64_tr_b16 v[228:229], v237 offset:6208
    ds_read_b64_tr_b16 v[230:231], v237 offset:9280
    s_waitcnt lgkmcnt(6)
    v_mfma_f32_32x32x16_bf16 v[120:135], v[216:219], v[184:187], v[120:135]
    ds_read_b64_tr_b16 v[216:217], v236 offset:6272
    ds_read_b64_tr_b16 v[218:219], v236 offset:9344
    s_waitcnt lgkmcnt(6)
    v_mfma_f32_32x32x16_bf16 v[136:151], v[220:223], v[184:187], v[136:151]
    ds_read_b64_tr_b16 v[220:221], v237 offset:6336
    ds_read_b64_tr_b16 v[222:223], v237 offset:9408
    s_waitcnt lgkmcnt(6)
    v_mfma_f32_32x32x16_bf16 v[56:71], v[224:227], v[188:191], v[56:71]
    ds_read_b64_tr_b16 v[224:225], v236 offset:6400
    ds_read_b64_tr_b16 v[226:227], v236 offset:9472
    s_waitcnt lgkmcnt(6)
    v_mfma_f32_32x32x16_bf16 v[72:87], v[228:231], v[188:191], v[72:87]
    ds_read_b64_tr_b16 v[228:229], v237 offset:6464
    ds_read_b64_tr_b16 v[230:231], v237 offset:9536
    s_waitcnt lgkmcnt(6)
    v_mfma_f32_32x32x16_bf16 v[88:103], v[216:219], v[188:191], v[88:103]
    s_waitcnt lgkmcnt(4)
    v_mfma_f32_32x32x16_bf16 v[104:119], v[220:223], v[188:191], v[104:119]
    s_waitcnt lgkmcnt(2)
    v_mfma_f32_32x32x16_bf16 v[120:135], v[224:227], v[188:191], v[120:135]
    s_waitcnt lgkmcnt(0)
    v_mfma_f32_32x32x16_bf16 v[136:151], v[228:231], v[188:191], v[136:151]
    ds_read_b128 v[200:203], v232 offset:12288
    ds_read_b128 v[204:207], v233 offset:12288
    ds_read_b128 v[208:211], v234 offset:12288
    ds_read_b128 v[212:215], v235 offset:12288
    s_waitcnt lgkmcnt(3)
    v_mfma_f32_32x32x16_bf16 v[168:183], v[200:203], v[8:11], 0
    ds_read_b128 v[200:203], v232 offset:12416
    s_waitcnt lgkmcnt(3)
    v_mfma_f32_32x32x16_bf16 v[168:183], v[204:207], v[12:15], v[168:183]
    ds_read_b128 v[204:207], v233 offset:12416
    s_waitcnt lgkmcnt(3)
    v_mfma_f32_32x32x16_bf16 v[168:183], v[208:211], v[16:19], v[168:183]
    ds_read_b128 v[208:211], v234 offset:12416
    s_waitcnt lgkmcnt(3)
    v_mfma_f32_32x32x16_bf16 v[168:183], v[212:215], v[20:23], v[168:183]
    ds_read_b128 v[212:215], v235 offset:12416
    s_waitcnt lgkmcnt(3)
    v_mfma_f32_32x32x16_bf16 v[168:183], v[200:203], v[24:27], v[168:183]
    ds_read_b128 v[200:203], v232 offset:12544
    s_waitcnt lgkmcnt(3)
    v_mfma_f32_32x32x16_bf16 v[168:183], v[204:207], v[28:31], v[168:183]
    ds_read_b128 v[204:207], v233 offset:12544
    s_waitcnt lgkmcnt(3)
    v_mfma_f32_32x32x16_bf16 v[168:183], v[208:211], v[32:35], v[168:183]
    ds_read_b128 v[208:211], v234 offset:12544
    s_waitcnt lgkmcnt(3)
    v_mfma_f32_32x32x16_bf16 v[168:183], v[212:215], v[36:39], v[168:183]
    ds_read_b128 v[212:215], v235 offset:12544
    s_waitcnt lgkmcnt(3)
    v_mfma_f32_32x32x16_bf16 v[168:183], v[200:203], v[40:43], v[168:183]
    s_waitcnt lgkmcnt(2)
    v_mfma_f32_32x32x16_bf16 v[168:183], v[204:207], v[44:47], v[168:183]
    s_waitcnt lgkmcnt(1)
    v_mfma_f32_32x32x16_bf16 v[168:183], v[208:211], v[48:51], v[168:183]
    s_waitcnt lgkmcnt(0)
    v_mfma_f32_32x32x16_bf16 v[168:183], v[212:215], v[52:55], v[168:183]
    s_nop 7
    s_nop 7
    v_max3_f32 v246, v168, v169, v170
    v_max3_f32 v246, v246, v171, v172
    v_max3_f32 v246, v246, v173, v174
    v_max3_f32 v246, v246, v175, v176
    v_max3_f32 v246, v246, v177, v178
    v_max3_f32 v246, v246, v179, v180
    v_max3_f32 v246, v246, v181, v182
    v_max_f32 v246, v246, v183
    v_mov_b32 v247, v246
    v_mov_b32 v248, v246
    s_nop 1
    v_permlane32_swap_b32 v247, v248
    s_nop 1
    v_max3_f32 v246, v247, v248, v244
    v_add_f32 v249, s44, v244
    v_cmp_gt_f32 vcc, v246, v249
    s_nop 4
    s_cbranch_vccz L_attn_skip01
    v_sub_f32 v247, v244, v246
    v_mul_f32 v247, s40, v247
    v_exp_f32 v247, v247
    v_mov_b32 v244, v246
    v_mul_f32 v245, v245, v247
    v_mul_f32 v56, v56, v247
    v_mul_f32 v57, v57, v247
    v_mul_f32 v58, v58, v247
    v_mul_f32 v59, v59, v247
    v_mul_f32 v60, v60, v247
    v_mul_f32 v61, v61, v247
    v_mul_f32 v62, v62, v247
    v_mul_f32 v63, v63, v247
    v_mul_f32 v64, v64, v247
    v_mul_f32 v65, v65, v247
    v_mul_f32 v66, v66, v247
    v_mul_f32 v67, v67, v247
    v_mul_f32 v68, v68, v247
    v_mul_f32 v69, v69, v247
    v_mul_f32 v70, v70, v247
    v_mul_f32 v71, v71, v247
    v_mul_f32 v72, v72, v247
    v_mul_f32 v73, v73, v247
    v_mul_f32 v74, v74, v247
    v_mul_f32 v75, v75, v247
    v_mul_f32 v76, v76, v247
    v_mul_f32 v77, v77, v247
    v_mul_f32 v78, v78, v247
    v_mul_f32 v79, v79, v247
    v_mul_f32 v80, v80, v247
    v_mul_f32 v81, v81, v247
    v_mul_f32 v82, v82, v247
    v_mul_f32 v83, v83, v247
    v_mul_f32 v84, v84, v247
    v_mul_f32 v85, v85, v247
    v_mul_f32 v86, v86, v247
    v_mul_f32 v87, v87, v247
    v_mul_f32 v88, v88, v247
    v_mul_f32 v89, v89, v247
    v_mul_f32 v90, v90, v247
    v_mul_f32 v91, v91, v247
    v_mul_f32 v92, v92, v247
    v_mul_f32 v93, v93, v247
    v_mul_f32 v94, v94, v247
    v_mul_f32 v95, v95, v247
    v_mul_f32 v96, v96, v247
    v_mul_f32 v97, v97, v247
    v_mul_f32 v98, v98, v247
    v_mul_f32 v99, v99, v247
    v_mul_f32 v100, v100, v247
    v_mul_f32 v101, v101, v247
    v_mul_f32 v102, v102, v247
    v_mul_f32 v103, v103, v247
    v_mul_f32 v104, v104, v247
    v_mul_f32 v105, v105, v247
    v_mul_f32 v106, v106, v247
    v_mul_f32 v107, v107, v247
    v_mul_f32 v108, v108, v247
    v_mul_f32 v109, v109, v247
    v_mul_f32 v110, v110, v247
    v_mul_f32 v111, v111, v247
    v_mul_f32 v112, v112, v247
    v_mul_f32 v113, v113, v247
    v_mul_f32 v114, v114, v247
    v_mul_f32 v115, v115, v247
    v_mul_f32 v116, v116, v247
    v_mul_f32 v117, v117, v247
    v_mul_f32 v118, v118, v247
    v_mul_f32 v119, v119, v247
    v_mul_f32 v120, v120, v247
    v_mul_f32 v121, v121, v247
    v_mul_f32 v122, v122, v247
    v_mul_f32 v123, v123, v247
    v_mul_f32 v124, v124, v247
    v_mul_f32 v125, v125, v247
    v_mul_f32 v126, v126, v247
    v_mul_f32 v127, v127, v247
    v_mul_f32 v128, v128, v247
    v_mul_f32 v129, v129, v247
    v_mul_f32 v130, v130, v247
    v_mul_f32 v131, v131, v247
    v_mul_f32 v132, v132, v247
    v_mul_f32 v133, v133, v247
    v_mul_f32 v134, v134, v247
    v_mul_f32 v135, v135, v247
    v_mul_f32 v136, v136, v247
    v_mul_f32 v137, v137, v247
    v_mul_f32 v138, v138, v247
    v_mul_f32 v139, v139, v247
    v_mul_f32 v140, v140, v247
    v_mul_f32 v141, v141, v247
    v_mul_f32 v142, v142, v247
    v_mul_f32 v143, v143, v247
    v_mul_f32 v144, v144, v247
    v_mul_f32 v145, v145, v247
    v_mul_f32 v146, v146, v247
    v_mul_f32 v147, v147, v247
    v_mul_f32 v148, v148, v247
    v_mul_f32 v149, v149, v247
    v_mul_f32 v150, v150, v247
    v_mul_f32 v151, v151, v247
L_attn_skip01:
    v_mul_f32 v248, s40, v244
    v_fma_f32 v168, v168, s40, -v248
    v_exp_f32 v168, v168
    v_fma_f32 v169, v169, s40, -v248
    v_exp_f32 v169, v169
    v_fma_f32 v170, v170, s40, -v248
    v_exp_f32 v170, v170
    v_fma_f32 v171, v171, s40, -v248
    v_exp_f32 v171, v171
    v_fma_f32 v172, v172, s40, -v248
    v_exp_f32 v172, v172
    v_fma_f32 v173, v173, s40, -v248
    v_exp_f32 v173, v173
    v_fma_f32 v174, v174, s40, -v248
    v_exp_f32 v174, v174
    v_fma_f32 v175, v175, s40, -v248
    v_exp_f32 v175, v175
    v_fma_f32 v176, v176, s40, -v248
    v_exp_f32 v176, v176
    v_fma_f32 v177, v177, s40, -v248
    v_exp_f32 v177, v177
    v_fma_f32 v178, v178, s40, -v248
    v_exp_f32 v178, v178
    v_fma_f32 v179, v179, s40, -v248
    v_exp_f32 v179, v179
    v_fma_f32 v180, v180, s40, -v248
    v_exp_f32 v180, v180
    v_fma_f32 v181, v181, s40, -v248
    v_exp_f32 v181, v181
    v_fma_f32 v182, v182, s40, -v248
    v_exp_f32 v182, v182
    v_fma_f32 v183, v183, s40, -v248
    v_exp_f32 v183, v183
    v_add_f32 v245, v245, v168
    v_add_f32 v245, v245, v169
    v_add_f32 v245, v245, v170
    v_add_f32 v245, v245, v171
    v_add_f32 v245, v245, v172
    v_add_f32 v245, v245, v173
    v_add_f32 v245, v245, v174
    v_add_f32 v245, v245, v175
    v_add_f32 v245, v245, v176
    v_add_f32 v245, v245, v177
    v_add_f32 v245, v245, v178
    v_add_f32 v245, v245, v179
    v_add_f32 v245, v245, v180
    v_add_f32 v245, v245, v181
    v_add_f32 v245, v245, v182
    v_add_f32 v245, v245, v183
    v_cvt_pk_bf16_f32 v184, v168, v169
    v_cvt_pk_bf16_f32 v185, v170, v171
    v_cvt_pk_bf16_f32 v186, v172, v173
    v_cvt_pk_bf16_f32 v187, v174, v175
    v_cvt_pk_bf16_f32 v188, v176, v177
    v_cvt_pk_bf16_f32 v189, v178, v179
    v_cvt_pk_bf16_f32 v190, v180, v181
    v_cvt_pk_bf16_f32 v191, v182, v183
    s_nop 1
    ds_read_b64_tr_b16 v[216:217], v236 offset:12288
    ds_read_b64_tr_b16 v[218:219], v236 offset:15360
    ds_read_b64_tr_b16 v[220:221], v237 offset:12352
    ds_read_b64_tr_b16 v[222:223], v237 offset:15424
    ds_read_b64_tr_b16 v[224:225], v236 offset:12416
    ds_read_b64_tr_b16 v[226:227], v236 offset:15488
    ds_read_b64_tr_b16 v[228:229], v237 offset:12480
    ds_read_b64_tr_b16 v[230:231], v237 offset:15552
    s_waitcnt lgkmcnt(6)
    v_mfma_f32_32x32x16_bf16 v[56:71], v[216:219], v[184:187], v[56:71]
    ds_read_b64_tr_b16 v[216:217], v236 offset:12544
    ds_read_b64_tr_b16 v[218:219], v236 offset:15616
    s_waitcnt lgkmcnt(6)
    v_mfma_f32_32x32x16_bf16 v[72:87], v[220:223], v[184:187], v[72:87]
    ds_read_b64_tr_b16 v[220:221], v237 offset:12608
    ds_read_b64_tr_b16 v[222:223], v237 offset:15680
    s_waitcnt lgkmcnt(6)
    v_mfma_f32_32x32x16_bf16 v[88:103], v[224:227], v[184:187], v[88:103]
    ds_read_b64_tr_b16 v[224:225], v236 offset:18432
    ds_read_b64_tr_b16 v[226:227], v236 offset:21504
    s_waitcnt lgkmcnt(6)
    v_mfma_f32_32x32x16_bf16 v[104:119], v[228:231], v[184:187], v[104:119]
    ds_read_b64_tr_b16 v[228:229], v237 offset:18496
    ds_read_b64_tr_b16 v[230:231], v237 offset:21568
    s_waitcnt lgkmcnt(6)
    v_mfma_f32_32x32x16_bf16 v[120:135], v[216:219], v[184:187], v[120:135]
    ds_read_b64_tr_b16 v[216:217], v236 offset:18560
    ds_read_b64_tr_b16 v[218:219], v236 offset:21632
    s_waitcnt lgkmcnt(6)
    v_mfma_f32_32x32x16_bf16 v[136:151], v[220:223], v[184:187], v[136:151]
    ds_read_b64_tr_b16 v[220:221], v237 offset:18624
    ds_read_b64_tr_b16 v[222:223], v237 offset:21696
    s_waitcnt lgkmcnt(6)
    v_mfma_f32_32x32x16_bf16 v[56:71], v[224:227], v[188:191], v[56:71]
    ds_read_b64_tr_b16 v[224:225], v236 offset:18688
    ds_read_b64_tr_b16 v[226:227], v236 offset:21760
    s_waitcnt lgkmcnt(6)
    v_mfma_f32_32x32x16_bf16 v[72:87], v[228:231], v[188:191], v[72:87]
    ds_read_b64_tr_b16 v[228:229], v237 offset:18752
    ds_read_b64_tr_b16 v[230:231], v237 offset:21824
    s_waitcnt lgkmcnt(6)
    v_mfma_f32_32x32x16_bf16 v[88:103], v[216:219], v[188:191], v[88:103]
    s_waitcnt lgkmcnt(4)
    v_mfma_f32_32x32x16_bf16 v[104:119], v[220:223], v[188:191], v[104:119]
    s_waitcnt lgkmcnt(2)
    v_mfma_f32_32x32x16_bf16 v[120:135], v[224:227], v[188:191], v[120:135]
    s_waitcnt lgkmcnt(0)
    v_mfma_f32_32x32x16_bf16 v[136:151], v[228:231], v[188:191], v[136:151]
    s_waitcnt vmcnt(0)
    s_barrier
    s_add_u32 s42, s42, 24576
    s_cmp_eq_u32 s43, 30
    s_cbranch_scc1 L_attn_nopf
    s_add_u32 s14, s41, 0
    s_mov_b32 m0, s14
    s_add_u32 s14, s41, 49152
    buffer_load_dwordx4 v238, s[32:35], s42 offen lds
    s_mov_b32 m0, s14
    s_nop 0
    buffer_load_dwordx4 v241, s[36:39], s42 offen lds
    s_add_u32 s14, s41, 1024
    s_mov_b32 m0, s14
    s_add_u32 s14, s41, 50176
    buffer_load_dwordx4 v239, s[32:35], s42 offen lds
    s_mov_b32 m0, s14
    s_nop 0
    buffer_load_dwordx4 v242, s[36:39], s42 offen lds
    s_add_u32 s14, s41, 2048
    s_mov_b32 m0, s14
    s_add_u32 s14, s41, 51200
    buffer_load_dwordx4 v240, s[32:35], s42 offen lds
    s_mov_b32 m0, s14
    s_nop 0
    buffer_load_dwordx4 v243, s[36:39], s42 offen lds
L_attn_nopf:
    ds_read_b128 v[200:203], v232 offset:24576
    ds_read_b128 v[204:207], v233 offset:24576
    ds_read_b128 v[208:211], v234 offset:24576
    ds_read_b128 v[212:215], v235 offset:24576
    s_waitcnt lgkmcnt(3)
    v_mfma_f32_32x32x16_bf16 v[152:167], v[200:203], v[8:11], 0
    ds_read_b128 v[200:203], v232 offset:24704
    s_waitcnt lgkmcnt(3)
    v_mfma_f32_32x32x16_bf16 v[152:167], v[204:207], v[12:15], v[152:167]
    ds_read_b128 v[204:207], v233 offset:24704
    s_waitcnt lgkmcnt(3)
    v_mfma_f32_32x32x16_bf16 v[152:167], v[208:211], v[16:19], v[152:167]
    ds_read_b128 v[208:211], v234 offset:24704
    s_waitcnt lgkmcnt(3)
    v_mfma_f32_32x32x16_bf16 v[152:167], v[212:215], v[20:23], v[152:167]
    ds_read_b128 v[212:215], v235 offset:24704
    s_waitcnt lgkmcnt(3)
    v_mfma_f32_32x32x16_bf16 v[152:167], v[200:203], v[24:27], v[152:167]
    ds_read_b128 v[200:203], v232 offset:24832
    s_waitcnt lgkmcnt(3)
    v_mfma_f32_32x32x16_bf16 v[152:167], v[204:207], v[28:31], v[152:167]
    ds_read_b128 v[204:207], v233 offset:24832
    s_waitcnt lgkmcnt(3)
    v_mfma_f32_32x32x16_bf16 v[152:167], v[208:211], v[32:35], v[152:167]
    ds_read_b128 v[208:211], v234 offset:24832
    s_waitcnt lgkmcnt(3)
    v_mfma_f32_32x32x16_bf16 v[152:167], v[212:215], v[36:39], v[152:167]
    ds_read_b128 v[212:215], v235 offset:24832
    s_waitcnt lgkmcnt(3)
    v_mfma_f32_32x32x16_bf16 v[152:167], v[200:203], v[40:43], v[152:167]
    s_waitcnt lgkmcnt(2)
    v_mfma_f32_32x32x16_bf16 v[152:167], v[204:207], v[44:47], v[152:167]
    s_waitcnt lgkmcnt(1)
    v_mfma_f32_32x32x16_bf16 v[152:167], v[208:211], v[48:51], v[152:167]
    s_waitcnt lgkmcnt(0)
    v_mfma_f32_32x32x16_bf16 v[152:167], v[212:215], v[52:55], v[152:167]
    s_nop 7
    s_nop 7
    v_max3_f32 v246, v152, v153, v154
    v_max3_f32 v246, v246, v155, v156
    v_max3_f32 v246, v246, v157, v158
    v_max3_f32 v246, v246, v159, v160
    v_max3_f32 v246, v246, v161, v162
    v_max3_f32 v246, v246, v163, v164
    v_max3_f32 v246, v246, v165, v166
    v_max_f32 v246, v246, v167
    v_mov_b32 v247, v246
    v_mov_b32 v248, v246
    s_nop 1
    v_permlane32_swap_b32 v247, v248
    s_nop 1
    v_max3_f32 v246, v247, v248, v244
    v_add_f32 v249, s44, v244
    v_cmp_gt_f32 vcc, v246, v249
    s_nop 4
    s_cbranch_vccz L_attn_skip10
    v_sub_f32 v247, v244, v246
    v_mul_f32 v247, s40, v247
    v_exp_f32 v247, v247
    v_mov_b32 v244, v246
    v_mul_f32 v245, v245, v247
    v_mul_f32 v56, v56, v247
    v_mul_f32 v57, v57, v247
    v_mul_f32 v58, v58, v247
    v_mul_f32 v59, v59, v247
    v_mul_f32 v60, v60, v247
    v_mul_f32 v61, v61, v247
    v_mul_f32 v62, v62, v247
    v_mul_f32 v63, v63, v247
    v_mul_f32 v64, v64, v247
    v_mul_f32 v65, v65, v247
    v_mul_f32 v66, v66, v247
    v_mul_f32 v67, v67, v247
    v_mul_f32 v68, v68, v247
    v_mul_f32 v69, v69, v247
    v_mul_f32 v70, v70, v247
    v_mul_f32 v71, v71, v247
    v_mul_f32 v72, v72, v247
    v_mul_f32 v73, v73, v247
    v_mul_f32 v74, v74, v247
    v_mul_f32 v75, v75, v247
    v_mul_f32 v76, v76, v247
    v_mul_f32 v77, v77, v247
    v_mul_f32 v78, v78, v247
    v_mul_f32 v79, v79, v247
    v_mul_f32 v80, v80, v247
    v_mul_f32 v81, v81, v247
    v_mul_f32 v82, v82, v247
    v_mul_f32 v83, v83, v247
    v_mul_f32 v84, v84, v247
    v_mul_f32 v85, v85, v247
    v_mul_f32 v86, v86, v247
    v_mul_f32 v87, v87, v247
    v_mul_f32 v88, v88, v247
    v_mul_f32 v89, v89, v247
    v_mul_f32 v90, v90, v247
    v_mul_f32 v91, v91, v247
    v_mul_f32 v92, v92, v247
    v_mul_f32 v93, v93, v247
    v_mul_f32 v94, v94, v247
    v_mul_f32 v95, v95, v247
    v_mul_f32 v96, v96, v247
    v_mul_f32 v97, v97, v247
    v_mul_f32 v98, v98, v247
    v_mul_f32 v99, v99, v247
    v_mul_f32 v100, v100, v247
    v_mul_f32 v101, v101, v247
    v_mul_f32 v102, v102, v247
    v_mul_f32 v103, v103, v247
    v_mul_f32 v104, v104, v247
    v_mul_f32 v105, v105, v247
    v_mul_f32 v106, v106, v247
    v_mul_f32 v107, v107, v247
    v_mul_f32 v108, v108, v247
    v_mul_f32 v109, v109, v247
    v_mul_f32 v110, v110, v247
    v_mul_f32 v111, v111, v247
    v_mul_f32 v112, v112, v247
    v_mul_f32 v113, v113, v247
    v_mul_f32 v114, v114, v247
    v_mul_f32 v115, v115, v247
    v_mul_f32 v116, v116, v247
    v_mul_f32 v117, v117, v247
    v_mul_f32 v118, v118, v247
    v_mul_f32 v119, v119, v247
    v_mul_f32 v120, v120, v247
    v_mul_f32 v121, v121, v247
    v_mul_f32 v122, v122, v247
    v_mul_f32 v123, v123, v247
    v_mul_f32 v124, v124, v247
    v_mul_f32 v125, v125, v247
    v_mul_f32 v126, v126, v247
    v_mul_f32 v127, v127, v247
    v_mul_f32 v128, v128, v247
    v_mul_f32 v129, v129, v247
    v_mul_f32 v130, v130, v247
    v_mul_f32 v131, v131, v247
    v_mul_f32 v132, v132, v247
    v_mul_f32 v133, v133, v247
    v_mul_f32 v134, v134, v247
    v_mul_f32 v135, v135, v247
    v_mul_f32 v136, v136, v247
    v_mul_f32 v137, v137, v247
    v_mul_f32 v138, v138, v247
    v_mul_f32 v139, v139, v247
    v_mul_f32 v140, v140, v247
    v_mul_f32 v141, v141, v247
    v_mul_f32 v142, v142, v247
    v_mul_f32 v143, v143, v247
    v_mul_f32 v144, v144, v247
    v_mul_f32 v145, v145, v247
    v_mul_f32 v146, v146, v247
    v_mul_f32 v147, v147, v247
    v_mul_f32 v148, v148, v247
    v_mul_f32 v149, v149, v247
    v_mul_f32 v150, v150, v247
    v_mul_f32 v151, v151, v247
L_attn_skip10:
    v_mul_f32 v248, s40, v244
    v_fma_f32 v152, v152, s40, -v248
    v_exp_f32 v152, v152
    v_fma_f32 v153, v153, s40, -v248
    v_exp_f32 v153, v153
    v_fma_f32 v154, v154, s40, -v248
    v_exp_f32 v154, v154
    v_fma_f32 v155, v155, s40, -v248
    v_exp_f32 v155, v155
    v_fma_f32 v156, v156, s40, -v248
    v_exp_f32 v156, v156
    v_fma_f32 v157, v157, s40, -v248
    v_exp_f32 v157, v157
    v_fma_f32 v158, v158, s40, -v248
    v_exp_f32 v158, v158
    v_fma_f32 v159, v159, s40, -v248
    v_exp_f32 v159, v159
    v_fma_f32 v160, v160, s40, -v248
    v_exp_f32 v160, v160
    v_fma_f32 v161, v161, s40, -v248
    v_exp_f32 v161, v161
    v_fma_f32 v162, v162, s40, -v248
    v_exp_f32 v162, v162
    v_fma_f32 v163, v163, s40, -v248
    v_exp_f32 v163, v163
    v_fma_f32 v164, v164, s40, -v248
    v_exp_f32 v164, v164
    v_fma_f32 v165, v165, s40, -v248
    v_exp_f32 v165, v165
    v_fma_f32 v166, v166, s40, -v248
    v_exp_f32 v166, v166
    v_fma_f32 v167, v167, s40, -v248
    v_exp_f32 v167, v167
    v_add_f32 v245, v245, v152
    v_add_f32 v245, v245, v153
    v_add_f32 v245, v245, v154
    v_add_f32 v245, v245, v155
    v_add_f32 v245, v245, v156
    v_add_f32 v245, v245, v157
    v_add_f32 v245, v245, v158
    v_add_f32 v245, v245, v159
    v_add_f32 v245, v245, v160
    v_add_f32 v245, v245, v161
    v_add_f32 v245, v245, v162
    v_add_f32 v245, v245, v163
    v_add_f32 v245, v245, v164
    v_add_f32 v245, v245, v165
    v_add_f32 v245, v245, v166
    v_add_f32 v245, v245, v167
    v_cvt_pk_bf16_f32 v184, v152, v153
    v_cvt_pk_bf16_f32 v185, v154, v155
    v_cvt_pk_bf16_f32 v186, v156, v157
    v_cvt_pk_bf16_f32 v187, v158, v159
    v_cvt_pk_bf16_f32 v188, v160, v161
    v_cvt_pk_bf16_f32 v189, v162, v163
    v_cvt_pk_bf16_f32 v190, v164, v165
    v_cvt_pk_bf16_f32 v191, v166, v167
    s_nop 1
    ds_read_b64_tr_b16 v[216:217], v236 offset:24576
    ds_read_b64_tr_b16 v[218:219], v236 offset:27648
    ds_read_b64_tr_b16 v[220:221], v237 offset:24640
    ds_read_b64_tr_b16 v[222:223], v237 offset:27712
    ds_read_b64_tr_b16 v[224:225], v236 offset:24704
    ds_read_b64_tr_b16 v[226:227], v236 offset:27776
    ds_read_b64_tr_b16 v[228:229], v237 offset:24768
    ds_read_b64_tr_b16 v[230:231], v237 offset:27840
    s_waitcnt lgkmcnt(6)
    v_mfma_f32_32x32x16_bf16 v[56:71], v[216:219], v[184:187], v[56:71]
    ds_read_b64_tr_b16 v[216:217], v236 offset:24832
    ds_read_b64_tr_b16 v[218:219], v236 offset:27904
    s_waitcnt lgkmcnt(6)
    v_mfma_f32_32x32x16_bf16 v[72:87], v[220:223], v[184:187], v[72:87]
    ds_read_b64_tr_b16 v[220:221], v237 offset:24896
    ds_read_b64_tr_b16 v[222:223], v237 offset:27968
    s_waitcnt lgkmcnt(6)
    v_mfma_f32_32x32x16_bf16 v[88:103], v[224:227], v[184:187], v[88:103]
    ds_read_b64_tr_b16 v[224:225], v236 offset:30720
    ds_read_b64_tr_b16 v[226:227], v236 offset:33792
    s_waitcnt lgkmcnt(6)
    v_mfma_f32_32x32x16_bf16 v[104:119], v[228:231], v[184:187], v[104:119]
    ds_read_b64_tr_b16 v[228:229], v237 offset:30784
    ds_read_b64_tr_b16 v[230:231], v237 offset:33856
    s_waitcnt lgkmcnt(6)
    v_mfma_f32_32x32x16_bf16 v[120:135], v[216:219], v[184:187], v[120:135]
    ds_read_b64_tr_b16 v[216:217], v236 offset:30848
    ds_read_b64_tr_b16 v[218:219], v236 offset:33920
    s_waitcnt lgkmcnt(6)
    v_mfma_f32_32x32x16_bf16 v[136:151], v[220:223], v[184:187], v[136:151]
    ds_read_b64_tr_b16 v[220:221], v237 offset:30912
    ds_read_b64_tr_b16 v[222:223], v237 offset:33984
    s_waitcnt lgkmcnt(6)
    v_mfma_f32_32x32x16_bf16 v[56:71], v[224:227], v[188:191], v[56:71]
    ds_read_b64_tr_b16 v[224:225], v236 offset:30976
    ds_read_b64_tr_b16 v[226:227], v236 offset:34048
    s_waitcnt lgkmcnt(6)
    v_mfma_f32_32x32x16_bf16 v[72:87], v[228:231], v[188:191], v[72:87]
    ds_read_b64_tr_b16 v[228:229], v237 offset:31040
    ds_read_b64_tr_b16 v[230:231], v237 offset:34112
    s_waitcnt lgkmcnt(6)
    v_mfma_f32_32x32x16_bf16 v[88:103], v[216:219], v[188:191], v[88:103]
    s_waitcnt lgkmcnt(4)
    v_mfma_f32_32x32x16_bf16 v[104:119], v[220:223], v[188:191], v[104:119]
    s_waitcnt lgkmcnt(2)
    v_mfma_f32_32x32x16_bf16 v[120:135], v[224:227], v[188:191], v[120:135]
    s_waitcnt lgkmcnt(0)
    v_mfma_f32_32x32x16_bf16 v[136:151], v[228:231], v[188:191], v[136:151]
    ds_read_b128 v[200:203], v232 offset:36864
    ds_read_b128 v[204:207], v233 offset:36864
    ds_read_b128 v[208:211], v234 offset:36864
    ds_read_b128 v[212:215], v235 offset:36864
    s_waitcnt lgkmcnt(3)
    v_mfma_f32_32x32x16_bf16 v[168:183], v[200:203], v[8:11], 0
    ds_read_b128 v[200:203], v232 offset:36992
    s_waitcnt lgkmcnt(3)
    v_mfma_f32_32x32x16_bf16 v[168:183], v[204:207], v[12:15], v[168:183]
    ds_read_b128 v[204:207], v233 offset:36992
    s_waitcnt lgkmcnt(3)
    v_mfma_f32_32x32x16_bf16 v[168:183], v[208:211], v[16:19], v[168:183]
    ds_read_b128 v[208:211], v234 offset:36992
    s_waitcnt lgkmcnt(3)
    v_mfma_f32_32x32x16_bf16 v[168:183], v[212:215], v[20:23], v[168:183]
    ds_read_b128 v[212:215], v235 offset:36992
    s_waitcnt lgkmcnt(3)
    v_mfma_f32_32x32x16_bf16 v[168:183], v[200:203], v[24:27], v[168:183]
    ds_read_b128 v[200:203], v232 offset:37120
    s_waitcnt lgkmcnt(3)
    v_mfma_f32_32x32x16_bf16 v[168:183], v[204:207], v[28:31], v[168:183]
    ds_read_b128 v[204:207], v233 offset:37120
    s_waitcnt lgkmcnt(3)
    v_mfma_f32_32x32x16_bf16 v[168:183], v[208:211], v[32:35], v[168:183]
    ds_read_b128 v[208:211], v234 offset:37120
    s_waitcnt lgkmcnt(3)
    v_mfma_f32_32x32x16_bf16 v[168:183], v[212:215], v[36:39], v[168:183]
    ds_read_b128 v[212:215], v235 offset:37120
    s_waitcnt lgkmcnt(3)
    v_mfma_f32_32x32x16_bf16 v[168:183], v[200:203], v[40:43], v[168:183]
    s_waitcnt lgkmcnt(2)
    v_mfma_f32_32x32x16_bf16 v[168:183], v[204:207], v[44:47], v[168:183]
    s_waitcnt lgkmcnt(1)
    v_mfma_f32_32x32x16_bf16 v[168:183], v[208:211], v[48:51], v[168:183]
    s_waitcnt lgkmcnt(0)
    v_mfma_f32_32x32x16_bf16 v[168:183], v[212:215], v[52:55], v[168:183]
    s_nop 7
    s_nop 7
    v_max3_f32 v246, v168, v169, v170
    v_max3_f32 v246, v246, v171, v172
    v_max3_f32 v246, v246, v173, v174
    v_max3_f32 v246, v246, v175, v176
    v_max3_f32 v246, v246, v177, v178
    v_max3_f32 v246, v246, v179, v180
    v_max3_f32 v246, v246, v181, v182
    v_max_f32 v246, v246, v183
    v_mov_b32 v247, v246
    v_mov_b32 v248, v246
    s_nop 1
    v_permlane32_swap_b32 v247, v248
    s_nop 1
    v_max3_f32 v246, v247, v248, v244
    v_add_f32 v249, s44, v244
    v_cmp_gt_f32 vcc, v246, v249
    s_nop 4
    s_cbranch_vccz L_attn_skip11
    v_sub_f32 v247, v244, v246
    v_mul_f32 v247, s40, v247
    v_exp_f32 v247, v247
    v_mov_b32 v244, v246
    v_mul_f32 v245, v245, v247
    v_mul_f32 v56, v56, v247
    v_mul_f32 v57, v57, v247
    v_mul_f32 v58, v58, v247
    v_mul_f32 v59, v59, v247
    v_mul_f32 v60, v60, v247
    v_mul_f32 v61, v61, v247
    v_mul_f32 v62, v62, v247
    v_mul_f32 v63, v63, v247
    v_mul_f32 v64, v64, v247
    v_mul_f32 v65, v65, v247
    v_mul_f32 v66, v66, v247
    v_mul_f32 v67, v67, v247
    v_mul_f32 v68, v68, v247
    v_mul_f32 v69, v69, v247
    v_mul_f32 v70, v70, v247
    v_mul_f32 v71, v71, v247
    v_mul_f32 v72, v72, v247
    v_mul_f32 v73, v73, v247
    v_mul_f32 v74, v74, v247
    v_mul_f32 v75, v75, v247
    v_mul_f32 v76, v76, v247
    v_mul_f32 v77, v77, v247
    v_mul_f32 v78, v78, v247
    v_mul_f32 v79, v79, v247
    v_mul_f32 v80, v80, v247
    v_mul_f32 v81, v81, v247
    v_mul_f32 v82, v82, v247
    v_mul_f32 v83, v83, v247
    v_mul_f32 v84, v84, v247
    v_mul_f32 v85, v85, v247
    v_mul_f32 v86, v86, v247
    v_mul_f32 v87, v87, v247
    v_mul_f32 v88, v88, v247
    v_mul_f32 v89, v89, v247
    v_mul_f32 v90, v90, v247
    v_mul_f32 v91, v91, v247
    v_mul_f32 v92, v92, v247
    v_mul_f32 v93, v93, v247
    v_mul_f32 v94, v94, v247
    v_mul_f32 v95, v95, v247
    v_mul_f32 v96, v96, v247
    v_mul_f32 v97, v97, v247
    v_mul_f32 v98, v98, v247
    v_mul_f32 v99, v99, v247
    v_mul_f32 v100, v100, v247
    v_mul_f32 v101, v101, v247
    v_mul_f32 v102, v102, v247
    v_mul_f32 v103, v103, v247
    v_mul_f32 v104, v104, v247
    v_mul_f32 v105, v105, v247
    v_mul_f32 v106, v106, v247
    v_mul_f32 v107, v107, v247
    v_mul_f32 v108, v108, v247
    v_mul_f32 v109, v109, v247
    v_mul_f32 v110, v110, v247
    v_mul_f32 v111, v111, v247
    v_mul_f32 v112, v112, v247
    v_mul_f32 v113, v113, v247
    v_mul_f32 v114, v114, v247
    v_mul_f32 v115, v115, v247
    v_mul_f32 v116, v116, v247
    v_mul_f32 v117, v117, v247
    v_mul_f32 v118, v118, v247
    v_mul_f32 v119, v119, v247
    v_mul_f32 v120, v120, v247
    v_mul_f32 v121, v121, v247
    v_mul_f32 v122, v122, v247
    v_mul_f32 v123, v123, v247
    v_mul_f32 v124, v124, v247
    v_mul_f32 v125, v125, v247
    v_mul_f32 v126, v126, v247
    v_mul_f32 v127, v127, v247
    v_mul_f32 v128, v128, v247
    v_mul_f32 v129, v129, v247
    v_mul_f32 v130, v130, v247
    v_mul_f32 v131, v131, v247
    v_mul_f32 v132, v132, v247
    v_mul_f32 v133, v133, v247
    v_mul_f32 v134, v134, v247
    v_mul_f32 v135, v135, v247
    v_mul_f32 v136, v136, v247
    v_mul_f32 v137, v137, v247
    v_mul_f32 v138, v138, v247
    v_mul_f32 v139, v139, v247
    v_mul_f32 v140, v140, v247
    v_mul_f32 v141, v141, v247
    v_mul_f32 v142, v142, v247
    v_mul_f32 v143, v143, v247
    v_mul_f32 v144, v144, v247
    v_mul_f32 v145, v145, v247
    v_mul_f32 v146, v146, v247
    v_mul_f32 v147, v147, v247
    v_mul_f32 v148, v148, v247
    v_mul_f32 v149, v149, v247
    v_mul_f32 v150, v150, v247
    v_mul_f32 v151, v151, v247
L_attn_skip11:
    v_mul_f32 v248, s40, v244
    v_fma_f32 v168, v168, s40, -v248
    v_exp_f32 v168, v168
    v_fma_f32 v169, v169, s40, -v248
    v_exp_f32 v169, v169
    v_fma_f32 v170, v170, s40, -v248
    v_exp_f32 v170, v170
    v_fma_f32 v171, v171, s40, -v248
    v_exp_f32 v171, v171
    v_fma_f32 v172, v172, s40, -v248
    v_exp_f32 v172, v172
    v_fma_f32 v173, v173, s40, -v248
    v_exp_f32 v173, v173
    v_fma_f32 v174, v174, s40, -v248
    v_exp_f32 v174, v174
    v_fma_f32 v175, v175, s40, -v248
    v_exp_f32 v175, v175
    v_fma_f32 v176, v176, s40, -v248
    v_exp_f32 v176, v176
    v_fma_f32 v177, v177, s40, -v248
    v_exp_f32 v177, v177
    v_fma_f32 v178, v178, s40, -v248
    v_exp_f32 v178, v178
    v_fma_f32 v179, v179, s40, -v248
    v_exp_f32 v179, v179
    v_fma_f32 v180, v180, s40, -v248
    v_exp_f32 v180, v180
    v_fma_f32 v181, v181, s40, -v248
    v_exp_f32 v181, v181
    v_fma_f32 v182, v182, s40, -v248
    v_exp_f32 v182, v182
    v_fma_f32 v183, v183, s40, -v248
    v_exp_f32 v183, v183
    v_add_f32 v245, v245, v168
    v_add_f32 v245, v245, v169
    v_add_f32 v245, v245, v170
    v_add_f32 v245, v245, v171
    v_add_f32 v245, v245, v172
    v_add_f32 v245, v245, v173
    v_add_f32 v245, v245, v174
    v_add_f32 v245, v245, v175
    v_add_f32 v245, v245, v176
    v_add_f32 v245, v245, v177
    v_add_f32 v245, v245, v178
    v_add_f32 v245, v245, v179
    v_add_f32 v245, v245, v180
    v_add_f32 v245, v245, v181
    v_add_f32 v245, v245, v182
    v_add_f32 v245, v245, v183
    v_cvt_pk_bf16_f32 v184, v168, v169
    v_cvt_pk_bf16_f32 v185, v170, v171
    v_cvt_pk_bf16_f32 v186, v172, v173
    v_cvt_pk_bf16_f32 v187, v174, v175
    v_cvt_pk_bf16_f32 v188, v176, v177
    v_cvt_pk_bf16_f32 v189, v178, v179
    v_cvt_pk_bf16_f32 v190, v180, v181
    v_cvt_pk_bf16_f32 v191, v182, v183
    s_nop 1
    ds_read_b64_tr_b16 v[216:217], v236 offset:36864
    ds_read_b64_tr_b16 v[218:219], v236 offset:39936
    ds_read_b64_tr_b16 v[220:221], v237 offset:36928
    ds_read_b64_tr_b16 v[222:223], v237 offset:40000
    ds_read_b64_tr_b16 v[224:225], v236 offset:36992
    ds_read_b64_tr_b16 v[226:227], v236 offset:40064
    ds_read_b64_tr_b16 v[228:229], v237 offset:37056
    ds_read_b64_tr_b16 v[230:231], v237 offset:40128
    s_waitcnt lgkmcnt(6)
    v_mfma_f32_32x32x16_bf16 v[56:71], v[216:219], v[184:187], v[56:71]
    ds_read_b64_tr_b16 v[216:217], v236 offset:37120
    ds_read_b64_tr_b16 v[218:219], v236 offset:40192
    s_waitcnt lgkmcnt(6)
    v_mfma_f32_32x32x16_bf16 v[72:87], v[220:223], v[184:187], v[72:87]
    ds_read_b64_tr_b16 v[220:221], v237 offset:37184
    ds_read_b64_tr_b16 v[222:223], v237 offset:40256
    s_waitcnt lgkmcnt(6)
    v_mfma_f32_32x32x16_bf16 v[88:103], v[224:227], v[184:187], v[88:103]
    ds_read_b64_tr_b16 v[224:225], v236 offset:43008
    ds_read_b64_tr_b16 v[226:227], v236 offset:46080
    s_waitcnt lgkmcnt(6)
    v_mfma_f32_32x32x16_bf16 v[104:119], v[228:231], v[184:187], v[104:119]
    ds_read_b64_tr_b16 v[228:229], v237 offset:43072
    ds_read_b64_tr_b16 v[230:231], v237 offset:46144
    s_waitcnt lgkmcnt(6)
    v_mfma_f32_32x32x16_bf16 v[120:135], v[216:219], v[184:187], v[120:135]
    ds_read_b64_tr_b16 v[216:217], v236 offset:43136
    ds_read_b64_tr_b16 v[218:219], v236 offset:46208
    s_waitcnt lgkmcnt(6)
    v_mfma_f32_32x32x16_bf16 v[136:151], v[220:223], v[184:187], v[136:151]
    ds_read_b64_tr_b16 v[220:221], v237 offset:43200
    ds_read_b64_tr_b16 v[222:223], v237 offset:46272
    s_waitcnt lgkmcnt(6)
    v_mfma_f32_32x32x16_bf16 v[56:71], v[224:227], v[188:191], v[56:71]
    ds_read_b64_tr_b16 v[224:225], v236 offset:43264
    ds_read_b64_tr_b16 v[226:227], v236 offset:46336
    s_waitcnt lgkmcnt(6)
    v_mfma_f32_32x32x16_bf16 v[72:87], v[228:231], v[188:191], v[72:87]
    ds_read_b64_tr_b16 v[228:229], v237 offset:43328
    ds_read_b64_tr_b16 v[230:231], v237 offset:46400
    s_waitcnt lgkmcnt(6)
    v_mfma_f32_32x32x16_bf16 v[88:103], v[216:219], v[188:191], v[88:103]
    s_waitcnt lgkmcnt(4)
    v_mfma_f32_32x32x16_bf16 v[104:119], v[220:223], v[188:191], v[104:119]
    s_waitcnt lgkmcnt(2)
    v_mfma_f32_32x32x16_bf16 v[120:135], v[224:227], v[188:191], v[120:135]
    s_waitcnt lgkmcnt(0)
    v_mfma_f32_32x32x16_bf16 v[136:151], v[228:231], v[188:191], v[136:151]
    s_add_u32 s43, s43, 2
    s_cmp_lt_u32 s43, 32
    s_cbranch_scc1 L_attn_loop
    s_nop 7
    s_nop 7
    s_add_u32 s12, s4, 36700160
    s_addc_u32 s13, s5, 0
    s_mov_b32 s28, s12
    s_and_b32 s29, s13, 0xffff
    s_mov_b32 s30, 25165824
    s_mov_b32 s31, 0x00020000
    v_mov_b32 v247, v245
    v_mov_b32 v248, v245
    s_nop 1
    v_permlane32_swap_b32 v247, v248
    s_nop 1
    v_add_f32 v246, v247, v248
    v_rcp_f32 v246, v246
    v_bfe_u32 v247, v0, 5, 1
    v_lshl_add_u32 v2, v247, 3, v2
    v_mul_f32 v56, v56, v246
    v_mul_f32 v57, v57, v246
    v_mul_f32 v58, v58, v246
    v_mul_f32 v59, v59, v246
    v_cvt_pk_bf16_f32 v250, v56, v57
    v_cvt_pk_bf16_f32 v251, v58, v59
    buffer_store_dwordx2 v[250:251], v2, s[28:31], 0 offen offset:0
    s_nop 1
    v_mul_f32 v60, v60, v246
    v_mul_f32 v61, v61, v246
    v_mul_f32 v62, v62, v246
    v_mul_f32 v63, v63, v246
    v_cvt_pk_bf16_f32 v250, v60, v61
    v_cvt_pk_bf16_f32 v251, v62, v63
    buffer_store_dwordx2 v[250:251], v2, s[28:31], 0 offen offset:16
    s_nop 1
    v_mul_f32 v64, v64, v246
    v_mul_f32 v65, v65, v246
    v_mul_f32 v66, v66, v246
    v_mul_f32 v67, v67, v246
    v_cvt_pk_bf16_f32 v250, v64, v65
    v_cvt_pk_bf16_f32 v251, v66, v67
    buffer_store_dwordx2 v[250:251], v2, s[28:31], 0 offen offset:32
    s_nop 1
    v_mul_f32 v68, v68, v246
    v_mul_f32 v69, v69, v246
    v_mul_f32 v70, v70, v246
    v_mul_f32 v71, v71, v246
    v_cvt_pk_bf16_f32 v250, v68, v69
    v_cvt_pk_bf16_f32 v251, v70, v71
    buffer_store_dwordx2 v[250:251], v2, s[28:31], 0 offen offset:48
    s_nop 1
    v_mul_f32 v72, v72, v246
    v_mul_f32 v73, v73, v246
    v_mul_f32 v74, v74, v246
    v_mul_f32 v75, v75, v246
    v_cvt_pk_bf16_f32 v250, v72, v73
    v_cvt_pk_bf16_f32 v251, v74, v75
    buffer_store_dwordx2 v[250:251], v2, s[28:31], 0 offen offset:64
    s_nop 1
    v_mul_f32 v76, v76, v246
    v_mul_f32 v77, v77, v246
    v_mul_f32 v78, v78, v246
    v_mul_f32 v79, v79, v246
    v_cvt_pk_bf16_f32 v250, v76, v77
    v_cvt_pk_bf16_f32 v251, v78, v79
    buffer_store_dwordx2 v[250:251], v2, s[28:31], 0 offen offset:80
    s_nop 1
    v_mul_f32 v80, v80, v246
    v_mul_f32 v81, v81, v246
    v_mul_f32 v82, v82, v246
    v_mul_f32 v83, v83, v246
    v_cvt_pk_bf16_f32 v250, v80, v81
    v_cvt_pk_bf16_f32 v251, v82, v83
    buffer_store_dwordx2 v[250:251], v2, s[28:31], 0 offen offset:96
    s_nop 1
    v_mul_f32 v84, v84, v246
    v_mul_f32 v85, v85, v246
    v_mul_f32 v86, v86, v246
    v_mul_f32 v87, v87, v246
    v_cvt_pk_bf16_f32 v250, v84, v85
    v_cvt_pk_bf16_f32 v251, v86, v87
    buffer_store_dwordx2 v[250:251], v2, s[28:31], 0 offen offset:112
    s_nop 1
    v_mul_f32 v88, v88, v246
    v_mul_f32 v89, v89, v246
    v_mul_f32 v90, v90, v246
    v_mul_f32 v91, v91, v246
    v_cvt_pk_bf16_f32 v250, v88, v89
    v_cvt_pk_bf16_f32 v251, v90, v91
    buffer_store_dwordx2 v[250:251], v2, s[28:31], 0 offen offset:128
    s_nop 1
    v_mul_f32 v92, v92, v246
    v_mul_f32 v93, v93, v246
    v_mul_f32 v94, v94, v246
    v_mul_f32 v95, v95, v246
    v_cvt_pk_bf16_f32 v250, v92, v93
    v_cvt_pk_bf16_f32 v251, v94, v95
    buffer_store_dwordx2 v[250:251], v2, s[28:31], 0 offen offset:144
    s_nop 1
    v_mul_f32 v96, v96, v246
    v_mul_f32 v97, v97, v246
    v_mul_f32 v98, v98, v246
    v_mul_f32 v99, v99, v246
    v_cvt_pk_bf16_f32 v250, v96, v97
    v_cvt_pk_bf16_f32 v251, v98, v99
    buffer_store_dwordx2 v[250:251], v2, s[28:31], 0 offen offset:160
    s_nop 1
    v_mul_f32 v100, v100, v246
    v_mul_f32 v101, v101, v246
    v_mul_f32 v102, v102, v246
    v_mul_f32 v103, v103, v246
    v_cvt_pk_bf16_f32 v250, v100, v101
    v_cvt_pk_bf16_f32 v251, v102, v103
    buffer_store_dwordx2 v[250:251], v2, s[28:31], 0 offen offset:176
    s_nop 1
    v_mul_f32 v104, v104, v246
    v_mul_f32 v105, v105, v246
    v_mul_f32 v106, v106, v246
    v_mul_f32 v107, v107, v246
    v_cvt_pk_bf16_f32 v250, v104, v105
    v_cvt_pk_bf16_f32 v251, v106, v107
    buffer_store_dwordx2 v[250:251], v2, s[28:31], 0 offen offset:192
    s_nop 1
    v_mul_f32 v108, v108, v246
    v_mul_f32 v109, v109, v246
    v_mul_f32 v110, v110, v246
    v_mul_f32 v111, v111, v246
    v_cvt_pk_bf16_f32 v250, v108, v109
    v_cvt_pk_bf16_f32 v251, v110, v111
    buffer_store_dwordx2 v[250:251], v2, s[28:31], 0 offen offset:208
    s_nop 1
    v_mul_f32 v112, v112, v246
    v_mul_f32 v113, v113, v246
    v_mul_f32 v114, v114, v246
    v_mul_f32 v115, v115, v246
    v_cvt_pk_bf16_f32 v250, v112, v113
    v_cvt_pk_bf16_f32 v251, v114, v115
    buffer_store_dwordx2 v[250:251], v2, s[28:31], 0 offen offset:224
    s_nop 1
    v_mul_f32 v116, v116, v246
    v_mul_f32 v117, v117, v246
    v_mul_f32 v118, v118, v246
    v_mul_f32 v119, v119, v246
    v_cvt_pk_bf16_f32 v250, v116, v117
    v_cvt_pk_bf16_f32 v251, v118, v119
    buffer_store_dwordx2 v[250:251], v2, s[28:31], 0 offen offset:240
    s_nop 1
    v_mul_f32 v120, v120, v246
    v_mul_f32 v121, v121, v246
    v_mul_f32 v122, v122, v246
    v_mul_f32 v123, v123, v246
    v_cvt_pk_bf16_f32 v250, v120, v121
    v_cvt_pk_bf16_f32 v251, v122, v123
    buffer_store_dwordx2 v[250:251], v2, s[28:31], 0 offen offset:256
    s_nop 1
    v_mul_f32 v124, v124, v246
    v_mul_f32 v125, v125, v246
    v_mul_f32 v126, v126, v246
    v_mul_f32 v127, v127, v246
    v_cvt_pk_bf16_f32 v250, v124, v125
    v_cvt_pk_bf16_f32 v251, v126, v127
    buffer_store_dwordx2 v[250:251], v2, s[28:31], 0 offen offset:272
    s_nop 1
    v_mul_f32 v128, v128, v246
    v_mul_f32 v129, v129, v246
    v_mul_f32 v130, v130, v246
    v_mul_f32 v131, v131, v246
    v_cvt_pk_bf16_f32 v250, v128, v129
    v_cvt_pk_bf16_f32 v251, v130, v131
    buffer_store_dwordx2 v[250:251], v2, s[28:31], 0 offen offset:288
    s_nop 1
    v_mul_f32 v132, v132, v246
    v_mul_f32 v133, v133, v246
    v_mul_f32 v134, v134, v246
    v_mul_f32 v135, v135, v246
    v_cvt_pk_bf16_f32 v250, v132, v133
    v_cvt_pk_bf16_f32 v251, v134, v135
    buffer_store_dwordx2 v[250:251], v2, s[28:31], 0 offen offset:304
    s_nop 1
    v_mul_f32 v136, v136, v246
    v_mul_f32 v137, v137, v246
    v_mul_f32 v138, v138, v246
    v_mul_f32 v139, v139, v246
    v_cvt_pk_bf16_f32 v250, v136, v137
    v_cvt_pk_bf16_f32 v251, v138, v139
    buffer_store_dwordx2 v[250:251], v2, s[28:31], 0 offen offset:320
    s_nop 1
    v_mul_f32 v140, v140, v246
    v_mul_f32 v141, v141, v246
    v_mul_f32 v142, v142, v246
    v_mul_f32 v143, v143, v246
    v_cvt_pk_bf16_f32 v250, v140, v141
    v_cvt_pk_bf16_f32 v251, v142, v143
    buffer_store_dwordx2 v[250:251], v2, s[28:31], 0 offen offset:336
    s_nop 1
    v_mul_f32 v144, v144, v246
    v_mul_f32 v145, v145, v246
    v_mul_f32 v146, v146, v246
    v_mul_f32 v147, v147, v246
    v_cvt_pk_bf16_f32 v250, v144, v145
    v_cvt_pk_bf16_f32 v251, v146, v147
    buffer_store_dwordx2 v[250:251], v2, s[28:31], 0 offen offset:352
    s_nop 1
    v_mul_f32 v148, v148, v246
    v_mul_f32 v149, v149, v246
    v_mul_f32 v150, v150, v246
    v_mul_f32 v151, v151, v246
    v_cvt_pk_bf16_f32 v250, v148, v149
    v_cvt_pk_bf16_f32 v251, v150, v151
    buffer_store_dwordx2 v[250:251], v2, s[28:31], 0 offen offset:368
    s_nop 1
L_attn_done:
    s_endpgm
.globl outk_kernel
.p2align 8
.type outk_kernel,@function
outk_kernel:
    s_cmp_ge_u32 s2, 400
    s_cbranch_scc1 L_outk_done
    s_load_dwordx2 s[4:5], s[0:1], 96
    s_load_dwordx2 s[6:7], s[0:1], 32
    s_load_dwordx2 s[8:9], s[0:1], 64
    v_lshrrev_b32 v1, 6, v0
    s_nop 0
    v_readfirstlane_b32 s3, v1
    s_and_b32 s24, s2, 15
    s_lshr_b32 s26, s2, 4
    s_mul_i32 s27, s26, 13108
    s_lshr_b32 s27, s27, 16
    s_mul_i32 s25, s27, 5
    s_sub_u32 s25, s26, s25
    s_waitcnt lgkmcnt(0)
    v_and_b32 v112, 31, v0
    v_bfe_u32 v113, v0, 5, 1
    s_lshr_b32 s20, s3, 1
    s_and_b32 s21, s3, 1
    s_mul_i32 s22, s20, 8192
    v_lshlrev_b32 v114, 7, v112
    v_add_u32 v114, s22, v114
    v_bfe_u32 v115, v0, 1, 3
    v_add_u32 v116, 0, v113
    v_xor_b32 v116, v116, v115
    v_lshl_add_u32 v2, v116, 4, v114
    v_add_u32 v116, 2, v113
    v_xor_b32 v116, v116, v115
    v_lshl_add_u32 v3, v116, 4, v114
    v_add_u32 v116, 4, v113
    v_xor_b32 v116, v116, v115
    v_lshl_add_u32 v4, v116, 4, v114
    v_add_u32 v116, 6, v113
    v_xor_b32 v116, v116, v115
    v_lshl_add_u32 v5, v116, 4, v114
    v_bfe_u32 v112, v0, 2, 2
    v_lshl_add_u32 v114, v113, 3, v112
    v_mul_u32_u24 v114, 256, v114
    v_and_b32 v115, 1, v0
    v_lshl_add_u32 v114, v115, 3, v114
    v_add_u32 v114, 16384, v114
    v_lshlrev_b32 v115, 2, v112
    v_bfe_u32 v116, v0, 4, 1
    v_bfe_u32 v117, v0, 1, 1
    v_lshl_add_u32 v116, v116, 1, v117
    s_mul_i32 s22, s21, 8
    v_add_u32 v116, s22, v116
    v_add_u32 v117, 0, v116
    v_xor_b32 v117, v117, v115
    v_lshl_add_u32 v6, v117, 4, v114
    v_add_u32 v117, 4, v116
    v_xor_b32 v117, v117, v115
    v_lshl_add_u32 v7, v117, 4, v114
    v_mov_b32 v48, 0
    v_mov_b32 v49, 0
    v_mov_b32 v50, 0
    v_mov_b32 v51, 0
    v_mov_b32 v52, 0
    v_mov_b32 v53, 0
    v_mov_b32 v54, 0
    v_mov_b32 v55, 0
    v_mov_b32 v56, 0
    v_mov_b32 v57, 0
    v_mov_b32 v58, 0
    v_mov_b32 v59, 0
    v_mov_b32 v60, 0
    v_mov_b32 v61, 0
    v_mov_b32 v62, 0
    v_mov_b32 v63, 0
    v_mov_b32 v64, 0
    v_mov_b32 v65, 0
    v_mov_b32 v66, 0
    v_mov_b32 v67, 0
    v_mov_b32 v68, 0
    v_mov_b32 v69, 0
    v_mov_b32 v70, 0
    v_mov_b32 v71, 0
    v_mov_b32 v72, 0
    v_mov_b32 v73, 0
    v_mov_b32 v74, 0
    v_mov_b32 v75, 0
    v_mov_b32 v76, 0
    v_mov_b32 v77, 0
    v_mov_b32 v78, 0
    v_mov_b32 v79, 0
    v_mov_b32 v80, 0
    v_mov_b32 v81, 0
    v_mov_b32 v82, 0
    v_mov_b32 v83, 0
    v_mov_b32 v84, 0
    v_mov_b32 v85, 0
    v_mov_b32 v86, 0
    v_mov_b32 v87, 0
    v_mov_b32 v88, 0
    v_mov_b32 v89, 0
    v_mov_b32 v90, 0
    v_mov_b32 v91, 0
    v_mov_b32 v92, 0
    v_mov_b32 v93, 0
    v_mov_b32 v94, 0
    v_mov_b32 v95, 0
    v_mov_b32 v96, 0
    v_mov_b32 v97, 0
    v_mov_b32 v98, 0
    v_mov_b32 v99, 0
    v_mov_b32 v100, 0
    v_mov_b32 v101, 0
    v_mov_b32 v102, 0
    v_mov_b32 v103, 0
    v_mov_b32 v104, 0
    v_mov_b32 v105, 0
    v_mov_b32 v106, 0
    v_mov_b32 v107, 0
    v_mov_b32 v108, 0
    v_mov_b32 v109, 0
    v_mov_b32 v110, 0
    v_mov_b32 v111, 0
    s_cmp_eq_u32 s27, 4
    s_cbranch_scc1 L_outk_g
    s_add_u32 s12, s4, 36700160
    s_addc_u32 s13, s5, 0
    s_mov_b32 s28, s12
    s_and_b32 s29, s13, 0xffff
    s_mov_b32 s30, 25165824
    s_mov_b32 s31, 0x00020000
    s_mov_b32 s32, s6
    s_and_b32 s33, s7, 0xffff
    s_mov_b32 s34, 7864320
    s_mov_b32 s35, 0x00020000
    v_and_b32 v112, 63, v0
    s_mul_i32 s22, s3, 256
    s_add_u32 s22, s22, 0
    v_add_u32 v113, s22, v112
    v_lshrrev_b32 v114, 3, v113
    v_and_b32 v115, 7, v113
    v_bfe_u32 v116, v114, 1, 3
    v_xor_b32 v115, v115, v116
    v_mul_u32_u24 v114, 12288, v114
    v_lshl_add_u32 v8, v115, 4, v114
    s_mul_i32 s22, s3, 256
    s_add_u32 s22, s22, 64
    v_add_u32 v113, s22, v112
    v_lshrrev_b32 v114, 3, v113
    v_and_b32 v115, 7, v113
    v_bfe_u32 v116, v114, 1, 3
    v_xor_b32 v115, v115, v116
    v_mul_u32_u24 v114, 12288, v114
    v_lshl_add_u32 v9, v115, 4, v114
    s_mul_i32 s22, s3, 256
    s_add_u32 s22, s22, 128
    v_add_u32 v113, s22, v112
    v_lshrrev_b32 v114, 3, v113
    v_and_b32 v115, 7, v113
    v_bfe_u32 v116, v114, 1, 3
    v_xor_b32 v115, v115, v116
    v_mul_u32_u24 v114, 12288, v114
    v_lshl_add_u32 v10, v115, 4, v114
    s_mul_i32 s22, s3, 256
    s_add_u32 s22, s22, 192
    v_add_u32 v113, s22, v112
    v_lshrrev_b32 v114, 3, v113
    v_and_b32 v115, 7, v113
    v_bfe_u32 v116, v114, 1, 3
    v_xor_b32 v115, v115, v116
    v_mul_u32_u24 v114, 12288, v114
    v_lshl_add_u32 v11, v115, 4, v114
    s_mul_i32 s22, s3, 256
    s_add_u32 s22, s22, 0
    v_add_u32 v113, s22, v112
    v_lshrrev_b32 v114, 4, v113
    v_and_b32 v115, 15, v113
    v_and_b32 v116, 3, v114
    v_lshlrev_b32 v116, 2, v116
    v_xor_b32 v115, v115, v116
    v_mul_u32_u24 v114, 1280, v114
    v_lshl_add_u32 v12, v115, 4, v114
    s_mul_i32 s22, s3, 256
    s_add_u32 s22, s22, 64
    v_add_u32 v113, s22, v112
    v_lshrrev_b32 v114, 4, v113
    v_and_b32 v115, 15, v113
    v_and_b32 v116, 3, v114
    v_lshlrev_b32 v116, 2, v116
    v_xor_b32 v115, v115, v116
    v_mul_u32_u24 v114, 1280, v114
    v_lshl_add_u32 v13, v115, 4, v114
    s_mul_i32 s22, s3, 256
    s_add_u32 s22, s22, 128
    v_add_u32 v113, s22, v112
    v_lshrrev_b32 v114, 4, v113
    v_and_b32 v115, 15, v113
    v_and_b32 v116, 3, v114
    v_lshlrev_b32 v116, 2, v116
    v_xor_b32 v115, v115, v116
    v_mul_u32_u24 v114, 1280, v114
    v_lshl_add_u32 v14, v115, 4, v114
    s_mul_i32 s22, s3, 256
    s_add_u32 s22, s22, 192
    v_add_u32 v113, s22, v112
    v_lshrrev_b32 v114, 4, v113
    v_and_b32 v115, 15, v113
    v_and_b32 v116, 3, v114
    v_lshlrev_b32 v116, 2, v116
    v_xor_b32 v115, v115, v116
    v_mul_u32_u24 v114, 1280, v114
    v_lshl_add_u32 v15, v115, 4, v114
    s_mul_i32 s44, s24, 1572864
    s_mul_i32 s46, s27, 3072
    s_add_u32 s44, s44, s46
    s_lshl_b32 s45, s25, 8
    s_mul_i32 s46, s27, 1966080
    s_add_u32 s45, s45, s46
    s_branch L_outk_go
L_outk_g:
    s_add_u32 s12, s4, 30408704
    s_addc_u32 s13, s5, 0
    s_mov_b32 s28, s12
    s_and_b32 s29, s13, 0xffff
    s_mov_b32 s30, 6291456
    s_mov_b32 s31, 0x00020000
    s_mov_b32 s32, s8
    s_and_b32 s33, s9, 0xffff
    s_mov_b32 s34, 1966080
    s_mov_b32 s35, 0x00020000
    v_and_b32 v112, 63, v0
    s_mul_i32 s22, s3, 256
    s_add_u32 s22, s22, 0
    v_add_u32 v113, s22, v112
    v_lshrrev_b32 v114, 3, v113
    v_and_b32 v115, 7, v113
    v_bfe_u32 v116, v114, 1, 3
    v_xor_b32 v115, v115, v116
    v_mul_u32_u24 v114, 3072, v114
    v_lshl_add_u32 v8, v115, 4, v114
    s_mul_i32 s22, s3, 256
    s_add_u32 s22, s22, 64
    v_add_u32 v113, s22, v112
    v_lshrrev_b32 v114, 3, v113
    v_and_b32 v115, 7, v113
    v_bfe_u32 v116, v114, 1, 3
    v_xor_b32 v115, v115, v116
    v_mul_u32_u24 v114, 3072, v114
    v_lshl_add_u32 v9, v115, 4, v114
    s_mul_i32 s22, s3, 256
    s_add_u32 s22, s22, 128
    v_add_u32 v113, s22, v112
    v_lshrrev_b32 v114, 3, v113
    v_and_b32 v115, 7, v113
    v_bfe_u32 v116, v114, 1, 3
    v_xor_b32 v115, v115, v116
    v_mul_u32_u24 v114, 3072, v114
    v_lshl_add_u32 v10, v115, 4, v114
    s_mul_i32 s22, s3, 256
    s_add_u32 s22, s22, 192
    v_add_u32 v113, s22, v112
    v_lshrrev_b32 v114, 3, v113
    v_and_b32 v115, 7, v113
    v_bfe_u32 v116, v114, 1, 3
    v_xor_b32 v115, v115, v116
    v_mul_u32_u24 v114, 3072, v114
    v_lshl_add_u32 v11, v115, 4, v114
    s_mul_i32 s22, s3, 256
    s_add_u32 s22, s22, 0
    v_add_u32 v113, s22, v112
    v_lshrrev_b32 v114, 4, v113
    v_and_b32 v115, 15, v113
    v_and_b32 v116, 3, v114
    v_lshlrev_b32 v116, 2, v116
    v_xor_b32 v115, v115, v116
    v_mul_u32_u24 v114, 1280, v114
    v_lshl_add_u32 v12, v115, 4, v114
    s_mul_i32 s22, s3, 256
    s_add_u32 s22, s22, 64
    v_add_u32 v113, s22, v112
    v_lshrrev_b32 v114, 4, v113
    v_and_b32 v115, 15, v113
    v_and_b32 v116, 3, v114
    v_lshlrev_b32 v116, 2, v116
    v_xor_b32 v115, v115, v116
    v_mul_u32_u24 v114, 1280, v114
    v_lshl_add_u32 v13, v115, 4, v114
    s_mul_i32 s22, s3, 256
    s_add_u32 s22, s22, 128
    v_add_u32 v113, s22, v112
    v_lshrrev_b32 v114, 4, v113
    v_and_b32 v115, 15, v113
    v_and_b32 v116, 3, v114
    v_lshlrev_b32 v116, 2, v116
    v_xor_b32 v115, v115, v116
    v_mul_u32_u24 v114, 1280, v114
    v_lshl_add_u32 v14, v115, 4, v114
    s_mul_i32 s22, s3, 256
    s_add_u32 s22, s22, 192
    v_add_u32 v113, s22, v112
    v_lshrrev_b32 v114, 4, v113
    v_and_b32 v115, 15, v113
    v_and_b32 v116, 3, v114
    v_lshlrev_b32 v116, 2, v116
    v_xor_b32 v115, v115, v116
    v_mul_u32_u24 v114, 1280, v114
    v_lshl_add_u32 v15, v115, 4, v114
    s_mul_i32 s44, s24, 393216
    s_lshl_b32 s45, s25, 8
L_outk_go:
    s_mul_i32 s22, s3, 4096
    s_add_u32 s22, s22, 0
    s_mov_b32 m0, s22
    s_add_u32 s22, s22, 1024
    buffer_load_dwordx4 v8, s[28:31], s44 offen lds
    s_mov_b32 m0, s22
    s_add_u32 s22, s22, 1024
    buffer_load_dwordx4 v9, s[28:31], s44 offen lds
    s_mov_b32 m0, s22
    s_add_u32 s22, s22, 1024
    buffer_load_dwordx4 v10, s[28:31], s44 offen lds
    s_mov_b32 m0, s22
    s_add_u32 s22, s22, 1024
    buffer_load_dwordx4 v11, s[28:31], s44 offen lds
    s_mul_i32 s22, s3, 4096
    s_add_u32 s22, s22, 16384
    s_mov_b32 m0, s22
    s_add_u32 s22, s22, 1024
    buffer_load_dwordx4 v12, s[32:35], s45 offen lds
    s_mov_b32 m0, s22
    s_add_u32 s22, s22, 1024
    buffer_load_dwordx4 v13, s[32:35], s45 offen lds
    s_mov_b32 m0, s22
    s_add_u32 s22, s22, 1024
    buffer_load_dwordx4 v14, s[32:35], s45 offen lds
    s_mov_b32 m0, s22
    s_add_u32 s22, s22, 1024
    buffer_load_dwordx4 v15, s[32:35], s45 offen lds
    s_add_u32 s44, s44, 128
    s_add_u32 s45, s45, 81920
    s_mul_i32 s22, s3, 4096
    s_add_u32 s22, s22, 32768
    s_mov_b32 m0, s22
    s_add_u32 s22, s22, 1024
    buffer_load_dwordx4 v8, s[28:31], s44 offen lds
    s_mov_b32 m0, s22
    s_add_u32 s22, s22, 1024
    buffer_load_dwordx4 v9, s[28:31], s44 offen lds
    s_mov_b32 m0, s22
    s_add_u32 s22, s22, 1024
    buffer_load_dwordx4 v10, s[28:31], s44 offen lds
    s_mov_b32 m0, s22
    s_add_u32 s22, s22, 1024
    buffer_load_dwordx4 v11, s[28:31], s44 offen lds
    s_mul_i32 s22, s3, 4096
    s_add_u32 s22, s22, 49152
    s_mov_b32 m0, s22
    s_add_u32 s22, s22, 1024
    buffer_load_dwordx4 v12, s[32:35], s45 offen lds
    s_mov_b32 m0, s22
    s_add_u32 s22, s22, 1024
    buffer_load_dwordx4 v13, s[32:35], s45 offen lds
    s_mov_b32 m0, s22
    s_add_u32 s22, s22, 1024
    buffer_load_dwordx4 v14, s[32:35], s45 offen lds
    s_mov_b32 m0, s22
    s_add_u32 s22, s22, 1024
    buffer_load_dwordx4 v15, s[32:35], s45 offen lds
    s_add_u32 s44, s44, 128
    s_add_u32 s45, s45, 81920
    s_mov_b32 s23, 0
L_outk_loop:
    s_waitcnt vmcnt(8)
    s_barrier
    ds_read_b128 v[16:19], v2 offset:0
    ds_read_b128 v[20:23], v2 offset:4096
    ds_read_b64_tr_b16 v[32:33], v6 offset:0
    ds_read_b64_tr_b16 v[34:35], v6 offset:1024
    ds_read_b64_tr_b16 v[36:37], v7 offset:0
    ds_read_b64_tr_b16 v[38:39], v7 offset:1024
    ds_read_b128 v[24:27], v3 offset:0
    ds_read_b128 v[28:31], v3 offset:4096
    ds_read_b64_tr_b16 v[40:41], v6 offset:4096
    ds_read_b64_tr_b16 v[42:43], v6 offset:5120
    ds_read_b64_tr_b16 v[44:45], v7 offset:4096
    ds_read_b64_tr_b16 v[46:47], v7 offset:5120
    s_waitcnt lgkmcnt(6)
    v_mfma_f32_32x32x16_bf16 v[48:63], v[32:35], v[16:19], v[48:63]
    s_mul_i32 s22, s3, 4096
    s_add_u32 s22, s22, 65536
    s_mov_b32 m0, s22
    s_nop 0
    buffer_load_dwordx4 v8, s[28:31], s44 offen lds
    v_mfma_f32_32x32x16_bf16 v[64:79], v[36:39], v[16:19], v[64:79]
    v_mfma_f32_32x32x16_bf16 v[80:95], v[32:35], v[20:23], v[80:95]
    s_mul_i32 s22, s3, 4096
    s_add_u32 s22, s22, 66560
    s_mov_b32 m0, s22
    s_nop 0
    buffer_load_dwordx4 v9, s[28:31], s44 offen lds
    v_mfma_f32_32x32x16_bf16 v[96:111], v[36:39], v[20:23], v[96:111]
    ds_read_b128 v[16:19], v4 offset:0
    ds_read_b128 v[20:23], v4 offset:4096
    ds_read_b64_tr_b16 v[32:33], v6 offset:8192
    ds_read_b64_tr_b16 v[34:35], v6 offset:9216
    ds_read_b64_tr_b16 v[36:37], v7 offset:8192
    ds_read_b64_tr_b16 v[38:39], v7 offset:9216
    s_waitcnt lgkmcnt(6)
    v_mfma_f32_32x32x16_bf16 v[48:63], v[40:43], v[24:27], v[48:63]
    s_mul_i32 s22, s3, 4096
    s_add_u32 s22, s22, 67584
    s_mov_b32 m0, s22
    s_nop 0
    buffer_load_dwordx4 v10, s[28:31], s44 offen lds
    v_mfma_f32_32x32x16_bf16 v[64:79], v[44:47], v[24:27], v[64:79]
    v_mfma_f32_32x32x16_bf16 v[80:95], v[40:43], v[28:31], v[80:95]
    s_mul_i32 s22, s3, 4096
    s_add_u32 s22, s22, 68608
    s_mov_b32 m0, s22
    s_nop 0
    buffer_load_dwordx4 v11, s[28:31], s44 offen lds
    v_mfma_f32_32x32x16_bf16 v[96:111], v[44:47], v[28:31], v[96:111]
    ds_read_b128 v[24:27], v5 offset:0
    ds_read_b128 v[28:31], v5 offset:4096
    ds_read_b64_tr_b16 v[40:41], v6 offset:12288
    ds_read_b64_tr_b16 v[42:43], v6 offset:13312
    ds_read_b64_tr_b16 v[44:45], v7 offset:12288
    ds_read_b64_tr_b16 v[46:47], v7 offset:13312
    s_waitcnt lgkmcnt(6)
    v_mfma_f32_32x32x16_bf16 v[48:63], v[32:35], v[16:19], v[48:63]
    s_mul_i32 s22, s3, 4096
    s_add_u32 s22, s22, 81920
    s_mov_b32 m0, s22
    s_nop 0
    buffer_load_dwordx4 v12, s[32:35], s45 offen lds
    v_mfma_f32_32x32x16_bf16 v[64:79], v[36:39], v[16:19], v[64:79]
    v_mfma_f32_32x32x16_bf16 v[80:95], v[32:35], v[20:23], v[80:95]
    s_mul_i32 s22, s3, 4096
    s_add_u32 s22, s22, 82944
    s_mov_b32 m0, s22
    s_nop 0
    buffer_load_dwordx4 v13, s[32:35], s45 offen lds
    v_mfma_f32_32x32x16_bf16 v[96:111], v[36:39], v[20:23], v[96:111]
    s_waitcnt lgkmcnt(0)
    v_mfma_f32_32x32x16_bf16 v[48:63], v[40:43], v[24:27], v[48:63]
    s_mul_i32 s22, s3, 4096
    s_add_u32 s22, s22, 83968
    s_mov_b32 m0, s22
    s_nop 0
    buffer_load_dwordx4 v14, s[32:35], s45 offen lds
    v_mfma_f32_32x32x16_bf16 v[64:79], v[44:47], v[24:27], v[64:79]
    v_mfma_f32_32x32x16_bf16 v[80:95], v[40:43], v[28:31], v[80:95]
    s_mul_i32 s22, s3, 4096
    s_add_u32 s22, s22, 84992
    s_mov_b32 m0, s22
    s_nop 0
    buffer_load_dwordx4 v15, s[32:35], s45 offen lds
    v_mfma_f32_32x32x16_bf16 v[96:111], v[44:47], v[28:31], v[96:111]
    s_add_u32 s44, s44, 128
    s_add_u32 s45, s45, 81920
    s_waitcnt vmcnt(8)
    s_barrier
    ds_read_b128 v[16:19], v2 offset:32768
    ds_read_b128 v[20:23], v2 offset:36864
    ds_read_b64_tr_b16 v[32:33], v6 offset:32768
    ds_read_b64_tr_b16 v[34:35], v6 offset:33792
    ds_read_b64_tr_b16 v[36:37], v7 offset:32768
    ds_read_b64_tr_b16 v[38:39], v7 offset:33792
    ds_read_b128 v[24:27], v3 offset:32768
    ds_read_b128 v[28:31], v3 offset:36864
    ds_read_b64_tr_b16 v[40:41], v6 offset:36864
    ds_read_b64_tr_b16 v[42:43], v6 offset:37888
    ds_read_b64_tr_b16 v[44:45], v7 offset:36864
    ds_read_b64_tr_b16 v[46:47], v7 offset:37888
    s_waitcnt lgkmcnt(6)
    v_mfma_f32_32x32x16_bf16 v[48:63], v[32:35], v[16:19], v[48:63]
    s_mul_i32 s22, s3, 4096
    s_add_u32 s22, s22, 0
    s_mov_b32 m0, s22
    s_nop 0
    buffer_load_dwordx4 v8, s[28:31], s44 offen lds
    v_mfma_f32_32x32x16_bf16 v[64:79], v[36:39], v[16:19], v[64:79]
    v_mfma_f32_32x32x16_bf16 v[80:95], v[32:35], v[20:23], v[80:95]
    s_mul_i32 s22, s3, 4096
    s_add_u32 s22, s22, 1024
    s_mov_b32 m0, s22
    s_nop 0
    buffer_load_dwordx4 v9, s[28:31], s44 offen lds
    v_mfma_f32_32x32x16_bf16 v[96:111], v[36:39], v[20:23], v[96:111]
    ds_read_b128 v[16:19], v4 offset:32768
    ds_read_b128 v[20:23], v4 offset:36864
    ds_read_b64_tr_b16 v[32:33], v6 offset:40960
    ds_read_b64_tr_b16 v[34:35], v6 offset:41984
    ds_read_b64_tr_b16 v[36:37], v7 offset:40960
    ds_read_b64_tr_b16 v[38:39], v7 offset:41984
    s_waitcnt lgkmcnt(6)
    v_mfma_f32_32x32x16_bf16 v[48:63], v[40:43], v[24:27], v[48:63]
    s_mul_i32 s22, s3, 4096
    s_add_u32 s22, s22, 2048
    s_mov_b32 m0, s22
    s_nop 0
    buffer_load_dwordx4 v10, s[28:31], s44 offen lds
    v_mfma_f32_32x32x16_bf16 v[64:79], v[44:47], v[24:27], v[64:79]
    v_mfma_f32_32x32x16_bf16 v[80:95], v[40:43], v[28:31], v[80:95]
    s_mul_i32 s22, s3, 4096
    s_add_u32 s22, s22, 3072
    s_mov_b32 m0, s22
    s_nop 0
    buffer_load_dwordx4 v11, s[28:31], s44 offen lds
    v_mfma_f32_32x32x16_bf16 v[96:111], v[44:47], v[28:31], v[96:111]
    ds_read_b128 v[24:27], v5 offset:32768
    ds_read_b128 v[28:31], v5 offset:36864
    ds_read_b64_tr_b16 v[40:41], v6 offset:45056
    ds_read_b64_tr_b16 v[42:43], v6 offset:46080
    ds_read_b64_tr_b16 v[44:45], v7 offset:45056
    ds_read_b64_tr_b16 v[46:47], v7 offset:46080
    s_waitcnt lgkmcnt(6)
    v_mfma_f32_32x32x16_bf16 v[48:63], v[32:35], v[16:19], v[48:63]
    s_mul_i32 s22, s3, 4096
    s_add_u32 s22, s22, 16384
    s_mov_b32 m0, s22
    s_nop 0
    buffer_load_dwordx4 v12, s[32:35], s45 offen lds
    v_mfma_f32_32x32x16_bf16 v[64:79], v[36:39], v[16:19], v[64:79]
    v_mfma_f32_32x32x16_bf16 v[80:95], v[32:35], v[20:23], v[80:95]
    s_mul_i32 s22, s3, 4096
    s_add_u32 s22, s22, 17408
    s_mov_b32 m0, s22
    s_nop 0
    buffer_load_dwordx4 v13, s[32:35], s45 offen lds
    v_mfma_f32_32x32x16_bf16 v[96:111], v[36:39], v[20:23], v[96:111]
    s_waitcnt lgkmcnt(0)
    v_mfma_f32_32x32x16_bf16 v[48:63], v[40:43], v[24:27], v[48:63]
    s_mul_i32 s22, s3, 4096
    s_add_u32 s22, s22, 18432
    s_mov_b32 m0, s22
    s_nop 0
    buffer_load_dwordx4 v14, s[32:35], s45 offen lds
    v_mfma_f32_32x32x16_bf16 v[64:79], v[44:47], v[24:27], v[64:79]
    v_mfma_f32_32x32x16_bf16 v[80:95], v[40:43], v[28:31], v[80:95]
    s_mul_i32 s22, s3, 4096
    s_add_u32 s22, s22, 19456
    s_mov_b32 m0, s22
    s_nop 0
    buffer_load_dwordx4 v15, s[32:35], s45 offen lds
    v_mfma_f32_32x32x16_bf16 v[96:111], v[44:47], v[28:31], v[96:111]
    s_add_u32 s44, s44, 128
    s_add_u32 s45, s45, 81920
    s_waitcnt vmcnt(8)
    s_barrier
    v_add_u32 v2, 65536, v2
    v_add_u32 v3, 65536, v3
    v_add_u32 v4, 65536, v4
    v_add_u32 v5, 65536, v5
    v_add_u32 v6, 65536, v6
    v_add_u32 v7, 65536, v7
    ds_read_b128 v[16:19], v2 offset:0
    ds_read_b128 v[20:23], v2 offset:4096
    ds_read_b64_tr_b16 v[32:33], v6 offset:0
    ds_read_b64_tr_b16 v[34:35], v6 offset:1024
    ds_read_b64_tr_b16 v[36:37], v7 offset:0
    ds_read_b64_tr_b16 v[38:39], v7 offset:1024
    ds_read_b128 v[24:27], v3 offset:0
    ds_read_b128 v[28:31], v3 offset:4096
    ds_read_b64_tr_b16 v[40:41], v6 offset:4096
    ds_read_b64_tr_b16 v[42:43], v6 offset:5120
    ds_read_b64_tr_b16 v[44:45], v7 offset:4096
    ds_read_b64_tr_b16 v[46:47], v7 offset:5120
    s_waitcnt lgkmcnt(6)
    v_mfma_f32_32x32x16_bf16 v[48:63], v[32:35], v[16:19], v[48:63]
    s_mul_i32 s22, s3, 4096
    s_add_u32 s22, s22, 32768
    s_mov_b32 m0, s22
    s_nop 0
    buffer_load_dwordx4 v8, s[28:31], s44 offen lds
    v_mfma_f32_32x32x16_bf16 v[64:79], v[36:39], v[16:19], v[64:79]
    v_mfma_f32_32x32x16_bf16 v[80:95], v[32:35], v[20:23], v[80:95]
    s_mul_i32 s22, s3, 4096
    s_add_u32 s22, s22, 33792
    s_mov_b32 m0, s22
    s_nop 0
    buffer_load_dwordx4 v9, s[28:31], s44 offen lds
    v_mfma_f32_32x32x16_bf16 v[96:111], v[36:39], v[20:23], v[96:111]
    ds_read_b128 v[16:19], v4 offset:0
    ds_read_b128 v[20:23], v4 offset:4096
    ds_read_b64_tr_b16 v[32:33], v6 offset:8192
    ds_read_b64_tr_b16 v[34:35], v6 offset:9216
    ds_read_b64_tr_b16 v[36:37], v7 offset:8192
    ds_read_b64_tr_b16 v[38:39], v7 offset:9216
    s_waitcnt lgkmcnt(6)
    v_mfma_f32_32x32x16_bf16 v[48:63], v[40:43], v[24:27], v[48:63]
    s_mul_i32 s22, s3, 4096
    s_add_u32 s22, s22, 34816
    s_mov_b32 m0, s22
    s_nop 0
    buffer_load_dwordx4 v10, s[28:31], s44 offen lds
    v_mfma_f32_32x32x16_bf16 v[64:79], v[44:47], v[24:27], v[64:79]
    v_mfma_f32_32x32x16_bf16 v[80:95], v[40:43], v[28:31], v[80:95]
    s_mul_i32 s22, s3, 4096
    s_add_u32 s22, s22, 35840
    s_mov_b32 m0, s22
    s_nop 0
    buffer_load_dwordx4 v11, s[28:31], s44 offen lds
    v_mfma_f32_32x32x16_bf16 v[96:111], v[44:47], v[28:31], v[96:111]
    ds_read_b128 v[24:27], v5 offset:0
    ds_read_b128 v[28:31], v5 offset:4096
    ds_read_b64_tr_b16 v[40:41], v6 offset:12288
    ds_read_b64_tr_b16 v[42:43], v6 offset:13312
    ds_read_b64_tr_b16 v[44:45], v7 offset:12288
    ds_read_b64_tr_b16 v[46:47], v7 offset:13312
    s_waitcnt lgkmcnt(6)
    v_mfma_f32_32x32x16_bf16 v[48:63], v[32:35], v[16:19], v[48:63]
    s_mul_i32 s22, s3, 4096
    s_add_u32 s22, s22, 49152
    s_mov_b32 m0, s22
    s_nop 0
    buffer_load_dwordx4 v12, s[32:35], s45 offen lds
    v_mfma_f32_32x32x16_bf16 v[64:79], v[36:39], v[16:19], v[64:79]
    v_mfma_f32_32x32x16_bf16 v[80:95], v[32:35], v[20:23], v[80:95]
    s_mul_i32 s22, s3, 4096
    s_add_u32 s22, s22, 50176
    s_mov_b32 m0, s22
    s_nop 0
    buffer_load_dwordx4 v13, s[32:35], s45 offen lds
    v_mfma_f32_32x32x16_bf16 v[96:111], v[36:39], v[20:23], v[96:111]
    s_waitcnt lgkmcnt(0)
    v_mfma_f32_32x32x16_bf16 v[48:63], v[40:43], v[24:27], v[48:63]
    s_mul_i32 s22, s3, 4096
    s_add_u32 s22, s22, 51200
    s_mov_b32 m0, s22
    s_nop 0
    buffer_load_dwordx4 v14, s[32:35], s45 offen lds
    v_mfma_f32_32x32x16_bf16 v[64:79], v[44:47], v[24:27], v[64:79]
    v_mfma_f32_32x32x16_bf16 v[80:95], v[40:43], v[28:31], v[80:95]
    s_mul_i32 s22, s3, 4096
    s_add_u32 s22, s22, 52224
    s_mov_b32 m0, s22
    s_nop 0
    buffer_load_dwordx4 v15, s[32:35], s45 offen lds
    v_mfma_f32_32x32x16_bf16 v[96:111], v[44:47], v[28:31], v[96:111]
    s_add_u32 s44, s44, 128
    s_add_u32 s45, s45, 81920
    v_subrev_u32 v2, 65536, v2
    v_subrev_u32 v3, 65536, v3
    v_subrev_u32 v4, 65536, v4
    v_subrev_u32 v5, 65536, v5
    v_subrev_u32 v6, 65536, v6
    v_subrev_u32 v7, 65536, v7
    s_add_u32 s23, s23, 3
    s_cmp_lt_u32 s23, 24
    s_cbranch_scc1 L_outk_loop
    s_waitcnt vmcnt(0)
    s_barrier
    s_nop 7
    s_nop 7
    s_add_u32 s12, s4, 61865984
    s_addc_u32 s13, s5, 0
    s_mov_b32 s36, s12
    s_and_b32 s37, s13, 0xffff
    s_mov_b32 s38, 26214400
    s_mov_b32 s39, 0x00020000
    v_and_b32 v112, 31, v0
    v_bfe_u32 v113, v0, 5, 1
    s_lshl_b32 s22, s24, 7
    s_lshl_b32 s46, s20, 6
    s_add_u32 s22, s22, s46
    v_add_u32 v112, s22, v112
    v_mul_u32_u24 v112, 2560, v112
    s_lshl_b32 s22, s25, 7
    s_lshl_b32 s46, s21, 6
    s_add_u32 s22, s22, s46
    v_lshlrev_b32 v113, 2, v113
    v_add_u32 v113, s22, v113
    v_lshl_add_u32 v112, v113, 2, v112
    s_mul_i32 s46, s27, 5242880
    s_add_u32 s47, s46, 81920
    buffer_store_dwordx4 v[48:51], v112, s[36:39], s46 offen offset:0
    buffer_store_dwordx4 v[52:55], v112, s[36:39], s46 offen offset:32
    buffer_store_dwordx4 v[56:59], v112, s[36:39], s46 offen offset:64
    buffer_store_dwordx4 v[60:63], v112, s[36:39], s46 offen offset:96
    buffer_store_dwordx4 v[64:67], v112, s[36:39], s46 offen offset:128
    buffer_store_dwordx4 v[68:71], v112, s[36:39], s46 offen offset:160
    buffer_store_dwordx4 v[72:75], v112, s[36:39], s46 offen offset:192
    buffer_store_dwordx4 v[76:79], v112, s[36:39], s46 offen offset:224
    buffer_store_dwordx4 v[80:83], v112, s[36:39], s47 offen offset:0
    buffer_store_dwordx4 v[84:87], v112, s[36:39], s47 offen offset:32
    buffer_store_dwordx4 v[88:91], v112, s[36:39], s47 offen offset:64
    buffer_store_dwordx4 v[92:95], v112, s[36:39], s47 offen offset:96
    buffer_store_dwordx4 v[96:99], v112, s[36:39], s47 offen offset:128
    buffer_store_dwordx4 v[100:103], v112, s[36:39], s47 offen offset:160
    buffer_store_dwordx4 v[104:107], v112, s[36:39], s47 offen offset:192
    buffer_store_dwordx4 v[108:111], v112, s[36:39], s47 offen offset:224
L_outk_done:
    s_endpgm
.globl fin_kernel
.p2align 8
.type fin_kernel,@function
fin_kernel:
    s_cmp_ge_u32 s2, 1280
    s_cbranch_scc1 L_fin_done
    s_load_dwordx2 s[4:5], s[0:1], 96
    s_load_dwordx2 s[10:11], s[0:1], 72
    s_load_dwordx2 s[14:15], s[0:1], 0
    s_load_dwordx2 s[16:17], s[0:1], 80
    s_waitcnt lgkmcnt(0)
    s_add_u32 s12, s4, 61865984
    s_addc_u32 s13, s5, 0
    s_mov_b32 s28, s12
    s_and_b32 s29, s13, 0xffff
    s_mov_b32 s30, 26214400
    s_mov_b32 s31, 0x00020000
    s_mov_b32 s36, s16
    s_and_b32 s37, s17, 0xffff
    s_mov_b32 s38, 2621440
    s_mov_b32 s39, 0x00020000
    s_mov_b32 s40, s10
    s_and_b32 s41, s11, 0xffff
    s_mov_b32 s42, 1280
    s_mov_b32 s43, 0x00020000
    s_mov_b32 s48, s14
    s_and_b32 s49, s15, 0xffff
    s_mov_b32 s50, 2621440
    s_mov_b32 s51, 0x00020000
    s_lshl_b32 s3, s2, 8
    v_add_u32 v1, s3, v0
    v_lshlrev_b32 v2, 4, v1
    v_lshlrev_b32 v3, 3, v1
    s_mov_b32 s20, 52429
    v_lshrrev_b32 v4, 5, v1
    v_mul_lo_u32 v4, v4, s20
    v_lshrrev_b32 v4, 18, v4
    v_mul_u32_u24 v4, 160, v4
    v_sub_u32 v4, v1, v4
    v_lshlrev_b32 v4, 3, v4
    s_mov_b32 s21, 0
    buffer_load_dwordx4 v[8:11], v2, s[28:31], s21 offen
    s_mov_b32 s21, 5242880
    buffer_load_dwordx4 v[12:15], v2, s[28:31], s21 offen
    s_mov_b32 s21, 10485760
    buffer_load_dwordx4 v[16:19], v2, s[28:31], s21 offen
    s_mov_b32 s21, 15728640
    buffer_load_dwordx4 v[20:23], v2, s[28:31], s21 offen
    s_mov_b32 s21, 20971520
    buffer_load_dwordx4 v[24:27], v2, s[28:31], s21 offen
    buffer_load_dwordx2 v[28:29], v4, s[40:43], 0 offen
    buffer_load_dwordx2 v[30:31], v3, s[48:51], 0 offen
    s_mov_b32 s54, 0x3fb8aa3b
    s_waitcnt vmcnt(0)
    v_add_f32 v8, v8, v12
    v_add_f32 v16, v16, v20
    v_add_f32 v8, v8, v16
    v_add_f32 v9, v9, v13
    v_add_f32 v17, v17, v21
    v_add_f32 v9, v9, v17
    v_add_f32 v10, v10, v14
    v_add_f32 v18, v18, v22
    v_add_f32 v10, v10, v18
    v_add_f32 v11, v11, v15
    v_add_f32 v19, v19, v23
    v_add_f32 v11, v11, v19
    v_cvt_pk_bf16_f32 v32, v8, v9
    v_lshlrev_b32 v8, 16, v32
    v_and_b32 v9, 0xffff0000, v32
    v_cvt_pk_bf16_f32 v32, v24, v25
    v_lshlrev_b32 v24, 16, v32
    v_and_b32 v25, 0xffff0000, v32
    v_lshlrev_b32 v33, 16, v28
    v_and_b32 v34, 0xffff0000, v28
    v_add_f32 v24, v24, v33
    v_add_f32 v25, v25, v34
    v_cvt_pk_bf16_f32 v32, v24, v25
    v_lshlrev_b32 v24, 16, v32
    v_and_b32 v25, 0xffff0000, v32
    v_mul_f32 v33, s54, v24
    v_exp_f32 v34, -v33
    s_nop 0
    v_add_f32 v34, 1.0, v34
    v_rcp_f32 v34, v34
    s_nop 0
    v_mul_f32 v24, v24, v34
    v_mul_f32 v33, s54, v25
    v_exp_f32 v34, -v33
    s_nop 0
    v_add_f32 v34, 1.0, v34
    v_rcp_f32 v34, v34
    s_nop 0
    v_mul_f32 v25, v25, v34
    v_cvt_pk_bf16_f32 v32, v24, v25
    v_lshlrev_b32 v24, 16, v32
    v_and_b32 v25, 0xffff0000, v32
    v_mul_f32 v8, v8, v24
    v_mul_f32 v9, v9, v25
    v_cvt_pk_bf16_f32 v32, v8, v9
    v_lshlrev_b32 v8, 16, v32
    v_and_b32 v9, 0xffff0000, v32
    v_lshlrev_b32 v33, 16, v30
    v_and_b32 v34, 0xffff0000, v30
    v_add_f32 v8, v8, v33
    v_add_f32 v9, v9, v34
    v_cvt_pk_bf16_f32 v32, v10, v11
    v_lshlrev_b32 v10, 16, v32
    v_and_b32 v11, 0xffff0000, v32
    v_cvt_pk_bf16_f32 v32, v26, v27
    v_lshlrev_b32 v26, 16, v32
    v_and_b32 v27, 0xffff0000, v32
    v_lshlrev_b32 v33, 16, v29
    v_and_b32 v34, 0xffff0000, v29
    v_add_f32 v26, v26, v33
    v_add_f32 v27, v27, v34
    v_cvt_pk_bf16_f32 v32, v26, v27
    v_lshlrev_b32 v26, 16, v32
    v_and_b32 v27, 0xffff0000, v32
    v_mul_f32 v33, s54, v26
    v_exp_f32 v34, -v33
    s_nop 0
    v_add_f32 v34, 1.0, v34
    v_rcp_f32 v34, v34
    s_nop 0
    v_mul_f32 v26, v26, v34
    v_mul_f32 v33, s54, v27
    v_exp_f32 v34, -v33
    s_nop 0
    v_add_f32 v34, 1.0, v34
    v_rcp_f32 v34, v34
    s_nop 0
    v_mul_f32 v27, v27, v34
    v_cvt_pk_bf16_f32 v32, v26, v27
    v_lshlrev_b32 v26, 16, v32
    v_and_b32 v27, 0xffff0000, v32
    v_mul_f32 v10, v10, v26
    v_mul_f32 v11, v11, v27
    v_cvt_pk_bf16_f32 v32, v10, v11
    v_lshlrev_b32 v10, 16, v32
    v_and_b32 v11, 0xffff0000, v32
    v_lshlrev_b32 v33, 16, v31
    v_and_b32 v34, 0xffff0000, v31
    v_add_f32 v10, v10, v33
    v_add_f32 v11, v11, v34
    v_cvt_pk_bf16_f32 v12, v8, v9
    v_cvt_pk_bf16_f32 v13, v10, v11
    buffer_store_dwordx2 v[12:13], v3, s[36:39], 0 offen
L_fin_done:
    s_endpgm
.section .rodata,"a"
.p2align 6
.amdhsa_kernel ln_kernel
  .amdhsa_next_free_vgpr 32
  .amdhsa_next_free_sgpr 102
  .amdhsa_accum_offset 32
  .amdhsa_group_segment_fixed_size 0
  .amdhsa_kernarg_size 104
  .amdhsa_user_sgpr_count 2
  .amdhsa_user_sgpr_kernarg_segment_ptr 1
  .amdhsa_system_sgpr_workgroup_id_x 1
.end_amdhsa_kernel
.p2align 6
.amdhsa_kernel proj_kernel
  .amdhsa_next_free_vgpr 144
  .amdhsa_next_free_sgpr 102
  .amdhsa_accum_offset 144
  .amdhsa_group_segment_fixed_size 0
  .amdhsa_kernarg_size 104
  .amdhsa_user_sgpr_count 2
  .amdhsa_user_sgpr_kernarg_segment_ptr 1
  .amdhsa_system_sgpr_workgroup_id_x 1
.end_amdhsa_kernel
.p2align 6
.amdhsa_kernel attn_kernel
  .amdhsa_next_free_vgpr 256
  .amdhsa_next_free_sgpr 102
  .amdhsa_accum_offset 256
  .amdhsa_group_segment_fixed_size 0
  .amdhsa_kernarg_size 104
  .amdhsa_user_sgpr_count 2
  .amdhsa_user_sgpr_kernarg_segment_ptr 1
  .amdhsa_system_sgpr_workgroup_id_x 1
.end_amdhsa_kernel
.p2align 6
.amdhsa_kernel outk_kernel
  .amdhsa_next_free_vgpr 120
  .amdhsa_next_free_sgpr 102
  .amdhsa_accum_offset 120
  .amdhsa_group_segment_fixed_size 0
  .amdhsa_kernarg_size 104
  .amdhsa_user_sgpr_count 2
  .amdhsa_user_sgpr_kernarg_segment_ptr 1
  .amdhsa_system_sgpr_workgroup_id_x 1
.end_amdhsa_kernel
.p2align 6
.amdhsa_kernel fin_kernel
  .amdhsa_next_free_vgpr 40
  .amdhsa_next_free_sgpr 102
  .amdhsa_accum_offset 40
  .amdhsa_group_segment_fixed_size 0
  .amdhsa_kernarg_size 104
  .amdhsa_user_sgpr_count 2
  .amdhsa_user_sgpr_kernarg_segment_ptr 1
  .amdhsa_system_sgpr_workgroup_id_x 1
.end_amdhsa_kernel
```
